```python
import torch

def _softmax(x, axis=-1):
    return torch.softmax(x, dim=axis)

def _gelu(x):
    return torch.nn.functional.gelu(x, approximate='tanh')

def _silu(x):
    return torch.nn.functional.silu(x)

def _sigmoid(x):
    return torch.sigmoid(x)

def _layernorm(x, axis=-1, eps=1e-05):
    m = x.mean(dim=axis, keepdim=True)
    v = x.var(dim=axis, keepdim=True, unbiased=False)
    return (x - m) / torch.sqrt(v + eps)

def _scatter_add(tgt, idx, src, axis=0):
    return tgt.clone().index_add_(axis, idx, src)

def _segment_sum(src, seg, n):
    out = torch.zeros((n,) + src.shape[1:], dtype=src.dtype)
    return out.index_add_(0, seg, src)

def _pad(x, pw):
    flat = tuple((v for pair in reversed(pw) for v in pair))
    return torch.nn.functional.pad(x, flat)
kernel_name = 'standalone__varlen_attn_packed__ragged'

def setup_inputs():

    _w = lambda a: (lambda t: t.to(torch.bfloat16) if t.is_floating_point() else t)(torch.as_tensor(a))
    cu = torch.tensor([0, 289, 520, 939, 1289, 1402, 1666, 1973, 2275], dtype=torch.int64)
    T, H, D = (int(cu[-1]), 16, 128)
    return {'q': _w((lambda *s: torch.randn(*s, dtype=torch.bfloat16) * 0.8)(T, H, D)), 'k': _w((lambda *s: torch.randn(*s, dtype=torch.bfloat16) * 0.8)(T, H, D)), 'v': _w((lambda *s: torch.randn(*s, dtype=torch.bfloat16) * 0.05)(T, H, D)), 'cu': _w(cu)}

def reference(q, k, v, cu):
    T, H, D = q.shape
    out = torch.zeros_like(q)
    scale = D ** (-0.5)
    outs = []
    for i in range(len(cu) - 1):
        s, e = (int(cu[i]), int(cu[i + 1]))
        qi, ki, vi = (q[s:e].clone(), k[s:e].clone(), v[s:e].clone())
        p = _softmax(torch.einsum('qhd,khd->hqk', qi, ki) * scale, axis=-1)
        outs.append(torch.einsum('hqk,khd->qhd', p, vi))
    return torch.concatenate(outs, axis=0)
```

```asm
; @launch grid=(256,1,1) block=(512,1,1) lds=163840
.amdgcn_target "amdgcn-amd-amdhsa--gfx950"
.text
.globl standalone__varlen_attn_packed__ragged_kernel
.p2align 12
.p2align 8
.type standalone__varlen_attn_packed__ragged_kernel,@function
standalone__varlen_attn_packed__ragged_kernel:
    s_load_dwordx8 s[4:11], s[0:1], 0
    s_getpc_b64 s[72:73]
L_pc:
    s_lshr_b32 s80, s2, 4
    s_lshl_b32 s69, s80, 5
    s_load_dwordx8 s[16:23], s[72:73], s69 offset:0x2db4
    v_mul_u32_u24 v15, 36, v0
    v_readfirstlane_b32 s56, v0
    global_load_dword v19, v15, s[72:73]
    s_cmp_ge_u32 s80, 16
    s_cbranch_scc1 L_end
    s_bitcmp0_b32 s56, 8
    s_cbranch_scc1 L_mainpro
    v_bfe_u32 v15, v0, 5, 2
    v_and_b32 v16, 3, v0
    v_xor_b32 v16, v16, v15
    v_and_or_b32 v15, v0, 12, v15
    v_lshlrev_b32 v15, 12, v15
    v_lshl_add_u32 v15, v16, 4, v15
    v_and_b32 v16, 16, v0
    v_lshl_add_u32 v15, v16, 2, v15
    v_bfe_u32 v16, v0, 7, 1
    v_lshl_add_u32 v1, v16, 16, v15
    v_add_u32 v2, 0x80, v1
    s_lshl_b32 s69, s2, 2
    s_lshr_b32 s69, 0x62407351, s69
    s_and_b32 s69, s69, 7
    s_and_b32 s57, s2, 8
    s_or_b32 s69, s69, s57
    s_lshl_b32 s57, s69, 8
    s_lshl_b32 s61, s56, 6
    s_and_b32 s61, s61, 0x3000
    s_mov_b32 s51, 0x20000
    s_mov_b32 s35, s51
    s_mov_b32 s60, 0
    s_add_u32 s92, s61, 98304
    v_lshlrev_b32 v21, 2, v0
    v_add_u32 v21, 157696, v21
    v_mov_b32 v13, 0
    ds_write_b32 v21, v13
    ds_write_b32 v21, v13 offset:4096
    s_lshl_b32 s80, s80, 8
    s_lshr_b32 s68, s56, 1
    s_add_u32 s80, s80, s68
    s_waitcnt lgkmcnt(0)
    s_load_dwordx8 s[24:31], s[72:73], s80 offset:0x2fb4
    s_load_dwordx2 s[12:13], s[0:1], 32
    s_add_u32 s94, s16, s17
    s_add_u32 s95, s18, s19
    s_add_u32 s48, s4, s57
    s_addc_u32 s49, s5, 0
    s_bitcmp1_b32 s21, 12
    s_cselect_b32 s50, s95, s94
    s_bfe_u32 s68, s21, 0xc0000
    s_add_u32 m0, s92, 0
    s_lshl_b32 s68, s68, 12
    buffer_load_dwordx4 v1, s[48:51], s68 offen  lds
    s_add_u32 m0, m0, 0x4000
    s_nop 0
    buffer_load_dwordx4 v2, s[48:51], s68 offen  lds
    s_add_u32 s16, s16, s57
    s_add_u32 s32, s6, s16
    s_addc_u32 s33, s7, 0
    s_sub_u32 s32, s32, 1024
    s_subb_u32 s33, s33, 0
    s_add_u32 s34, s17, 1024
    s_mov_b32 m0, s61
    s_nop 0
    buffer_load_dwordx4 v1, s[32:35], s60 offen offset:1024  lds
    s_add_u32 m0, s61, 0x4000
    s_nop 0
    buffer_load_dwordx4 v2, s[32:35], s60 offen offset:1024  lds
    s_bitcmp1_b32 s21, 28
    s_cselect_b32 s50, s95, s94
    s_bfe_u32 s68, s21, 0xc0010
    s_add_u32 m0, s92, 1024
    s_lshl_b32 s68, s68, 12
    buffer_load_dwordx4 v1, s[48:51], s68 offen  lds
    s_add_u32 m0, m0, 0x4000
    s_nop 0
    buffer_load_dwordx4 v2, s[48:51], s68 offen  lds
    s_bitcmp1_b32 s22, 12
    s_cselect_b32 s50, s95, s94
    s_bfe_u32 s68, s22, 0xc0000
    s_add_u32 m0, s92, 2048
    s_lshl_b32 s68, s68, 12
    buffer_load_dwordx4 v1, s[48:51], s68 offen  lds
    s_add_u32 m0, m0, 0x4000
    s_nop 0
    buffer_load_dwordx4 v2, s[48:51], s68 offen  lds
    s_bitcmp1_b32 s22, 28
    s_cselect_b32 s50, s95, s94
    s_bfe_u32 s68, s22, 0xc0010
    s_add_u32 m0, s92, 3072
    s_lshl_b32 s68, s68, 12
    buffer_load_dwordx4 v1, s[48:51], s68 offen  lds
    s_add_u32 m0, m0, 0x4000
    s_nop 0
    buffer_load_dwordx4 v2, s[48:51], s68 offen  lds
    s_mov_b32 s39, s51
    s_mov_b32 s43, s51
    s_mov_b32 s47, s51
    s_add_u32 s18, s18, s57
    s_add_u32 s36, s6, s18
    s_addc_u32 s37, s7, 0
    s_mov_b32 s38, s19
    s_and_b32 s97, s20, 0xfffff000
    s_lshr_b32 s93, s61, 4
    s_add_u32 s93, s93, 158720
    v_mov_b32 v23, L_cnt-L_pc
    s_add_u32 s68, s97, 3072
    s_add_u32 s40, s8, s16
    s_addc_u32 s41, s9, 0
    s_sub_u32 s40, s40, s68
    s_subb_u32 s41, s41, 0
    s_add_u32 s42, s17, s68
    s_add_u32 s68, s97, 2048
    s_add_u32 s44, s8, s18
    s_addc_u32 s45, s9, 0
    s_sub_u32 s44, s44, s68
    s_subb_u32 s45, s45, 0
    s_add_u32 s46, s19, s68
    v_bfe_u32 v15, v0, 2, 2
    v_lshlrev_b32 v15, 12, v15
    v_and_b32 v16, 3, v0
    v_lshl_add_u32 v15, v16, 4, v15
    v_and_b32 v16, 48, v0
    v_lshl_add_u32 v15, v16, 2, v15
    v_bfe_u32 v16, v0, 6, 2
    v_lshl_add_u32 v3, v16, 14, v15
    v_add_u32 v4, 0x10000, v3
    s_setprio 3
    s_branch L_common
L_mainpro:
    s_mov_b64 s[48:49], s[0:1]
    s_mov_b32 s50, 0
    s_mov_b32 s51, 0x20000
    s_mov_b64 s[32:33], s[0:1]
    s_mov_b32 s34, 0
    s_mov_b32 s35, 0x20000
    s_mov_b64 s[36:37], s[0:1]
    s_mov_b32 s38, 0
    s_mov_b32 s39, 0x20000
    s_mov_b64 s[40:41], s[0:1]
    s_mov_b32 s42, 0
    s_mov_b32 s43, 0x20000
    s_mov_b64 s[44:45], s[0:1]
    s_mov_b32 s46, 0
    s_mov_b32 s47, 0x20000
    v_mov_b32 v1, 0
    v_mov_b32 v2, 0
    v_mov_b32 v3, 0
    v_mov_b32 v4, 0
    v_mov_b32 v23, 0
    s_lshl_b32 s69, s2, 2
    s_lshr_b32 s69, 0x62407351, s69
    s_and_b32 s69, s69, 7
    s_and_b32 s57, s2, 8
    s_or_b32 s69, s69, s57
    s_lshl_b32 s57, s69, 8
    v_lshlrev_b32 v21, 2, v0
    v_add_u32 v21, 157696, v21
    v_mov_b32 v13, 0
    ds_write_b32 v21, v13
    ds_write_b32 v21, v13 offset:4096
    s_lshl_b32 s80, s80, 8
    s_lshr_b32 s68, s56, 1
    s_add_u32 s80, s80, s68
    s_waitcnt lgkmcnt(0)
    s_load_dwordx8 s[24:31], s[72:73], s80 offset:0x2fb4
    s_load_dwordx2 s[12:13], s[0:1], 32
L_common:
    s_lshr_b32 s56, s56, 6
    v_and_b32 v11, 63, v0
    v_and_b32 v15, 7, v0
    v_mul_u32_u24 v15, 0x104, v15
    v_add_u32 v0, 161792, v15
    v_add_u32 v21, 0x1000, v21
    s_barrier
    s_cmp_lt_u32 s56, 4
    s_cbranch_scc1 L_common2
    s_mov_b32 m0, s93
    v_add_u32 v23, 4, v23
    global_load_lds_dword v23, s[72:73]
    s_mov_b32 m0, s61
    s_nop 0
    buffer_load_dwordx4 v1, s[36:39], s60 offen  lds
    s_add_u32 m0, s61, 0x4000
    s_nop 0
    buffer_load_dwordx4 v2, s[36:39], s60 offen  lds
    s_mov_b32 m0, s93
    v_add_u32 v23, 4, v23
    global_load_lds_dword v23, s[72:73]
    s_add_u32 s60, s60, s97
    s_add_u32 s61, s61, 0x8000
    s_and_b32 s61, s61, 0x1ffff
L_common2:
    v_bfe_u32 v15, v11, 4, 1
    v_lshlrev_b32 v15, 13, v15
    v_bfe_u32 v16, v11, 1, 1
    v_lshl_add_u32 v15, v16, 12, v15
    v_and_b32 v16, 1, v11
    v_lshl_add_u32 v15, v16, 9, v15
    v_bfe_u32 v16, v11, 2, 2
    v_lshl_add_u32 v15, v16, 6, v15
    v_lshrrev_b32 v16, 5, v11
    v_and_b32 v17, 3, v11
    v_xor_b32 v16, v16, v17
    v_lshl_add_u32 v5, v16, 4, v15
    v_xor_b32 v6, 32, v5
    v_lshrrev_b32 v15, 5, v11
    v_lshlrev_b32 v15, 12, v15
    v_bfe_u32 v16, v11, 2, 2
    v_lshl_add_u32 v15, v16, 6, v15
    v_bfe_u32 v16, v11, 4, 1
    v_lshl_add_u32 v15, v16, 5, v15
    v_lshl_add_u32 v15, v17, 3, v15
    v_add_u32 v248, 0x800, v15
    s_mov_b32 s59, 0x45800000
    v_mul_u32_u24 v16, 0x104, v17
    v_add_u32 v9, 158720, v16
    s_mov_b32 s90, 0x8000
    v_mov_b32 v10, 0
    s_waitcnt lgkmcnt(0)
    s_and_b32 s63, s24, 0xff
    s_sub_u32 s68, s24, s63
    s_add_u32 s68, s68, s57
    s_add_u32 s52, s12, s68
    s_addc_u32 s53, s13, 0
    s_mov_b32 s54, s25
    s_mov_b32 s55, 0x20000
    s_and_b32 s58, s20, 0xff
    s_bfe_u32 s71, s26, 0x40008
    s_cbranch_scc1 L_work
    v_mov_b32 v22, 16384
    ds_write_b32 v21, v22
    s_cmp_lt_u32 s56, 4
    s_cbranch_scc1 L_fin
    s_branch L_presig
L_work:
    v_pk_mov_b32 v[56:57], 0, 0
    v_pk_mov_b32 v[58:59], 0, 0
    v_pk_mov_b32 v[60:61], 0, 0
    v_pk_mov_b32 v[62:63], 0, 0
    v_pk_mov_b32 v[64:65], 0, 0
    v_pk_mov_b32 v[66:67], 0, 0
    v_pk_mov_b32 v[68:69], 0, 0
    v_pk_mov_b32 v[70:71], 0, 0
    v_pk_mov_b32 v[72:73], 0, 0
    v_pk_mov_b32 v[74:75], 0, 0
    v_pk_mov_b32 v[76:77], 0, 0
    v_pk_mov_b32 v[78:79], 0, 0
    v_pk_mov_b32 v[80:81], 0, 0
    v_pk_mov_b32 v[82:83], 0, 0
    v_pk_mov_b32 v[84:85], 0, 0
    v_pk_mov_b32 v[86:87], 0, 0
    v_pk_mov_b32 v[88:89], 0, 0
    v_pk_mov_b32 v[90:91], 0, 0
    v_pk_mov_b32 v[92:93], 0, 0
    v_pk_mov_b32 v[94:95], 0, 0
    v_pk_mov_b32 v[96:97], 0, 0
    v_pk_mov_b32 v[98:99], 0, 0
    v_pk_mov_b32 v[100:101], 0, 0
    v_pk_mov_b32 v[102:103], 0, 0
    v_pk_mov_b32 v[104:105], 0, 0
    v_pk_mov_b32 v[106:107], 0, 0
    v_pk_mov_b32 v[108:109], 0, 0
    v_pk_mov_b32 v[110:111], 0, 0
    v_pk_mov_b32 v[112:113], 0, 0
    v_pk_mov_b32 v[114:115], 0, 0
    v_pk_mov_b32 v[116:117], 0, 0
    v_pk_mov_b32 v[118:119], 0, 0
    s_and_b32 s62, s26, 0xff
    s_bfe_u32 s84, s26, 0x4000c
    s_and_b32 s81, s28, 0xfffff
    s_bfe_u32 s68, s26, 0x80010
    s_sub_u32 s68, s68, 1
    v_lshrrev_b32 v15, 5, v11
    v_lshlrev_b32 v15, 2, v15
    v_sub_u32 v15, s68, v15
    v_mov_b32 v16, 0xff800000
    v_subrev_u32 v136, 0, v15
    v_ashrrev_i32 v136, 31, v136
    v_and_b32 v136, v16, v136
    v_subrev_u32 v137, 1, v15
    v_ashrrev_i32 v137, 31, v137
    v_and_b32 v137, v16, v137
    v_subrev_u32 v138, 2, v15
    v_ashrrev_i32 v138, 31, v138
    v_and_b32 v138, v16, v138
    v_subrev_u32 v139, 3, v15
    v_ashrrev_i32 v139, 31, v139
    v_and_b32 v139, v16, v139
    v_subrev_u32 v140, 8, v15
    v_ashrrev_i32 v140, 31, v140
    v_and_b32 v140, v16, v140
    v_subrev_u32 v141, 9, v15
    v_ashrrev_i32 v141, 31, v141
    v_and_b32 v141, v16, v141
    v_subrev_u32 v142, 10, v15
    v_ashrrev_i32 v142, 31, v142
    v_and_b32 v142, v16, v142
    v_subrev_u32 v143, 11, v15
    v_ashrrev_i32 v143, 31, v143
    v_and_b32 v143, v16, v143
    v_subrev_u32 v144, 16, v15
    v_ashrrev_i32 v144, 31, v144
    v_and_b32 v144, v16, v144
    v_subrev_u32 v145, 17, v15
    v_ashrrev_i32 v145, 31, v145
    v_and_b32 v145, v16, v145
    v_subrev_u32 v146, 18, v15
    v_ashrrev_i32 v146, 31, v146
    v_and_b32 v146, v16, v146
    v_subrev_u32 v147, 19, v15
    v_ashrrev_i32 v147, 31, v147
    v_and_b32 v147, v16, v147
    v_subrev_u32 v148, 24, v15
    v_ashrrev_i32 v148, 31, v148
    v_and_b32 v148, v16, v148
    v_subrev_u32 v149, 25, v15
    v_ashrrev_i32 v149, 31, v149
    v_and_b32 v149, v16, v149
    v_subrev_u32 v150, 26, v15
    v_ashrrev_i32 v150, 31, v150
    v_and_b32 v150, v16, v150
    v_subrev_u32 v151, 27, v15
    v_ashrrev_i32 v151, 31, v151
    v_and_b32 v151, v16, v151
    s_bfe_u32 s68, s28, 0x20014
    s_lshl_b32 s68, s68, 10
    s_bfe_u32 s69, s28, 0x10016
    s_lshl_b32 s69, s69, 15
    s_add_u32 s68, s68, s69
    s_add_u32 s64, s68, 98304
    v_add_u32 v17, s64, v5
    v_add_u32 v18, s64, v6
    s_cmp_lg_u32 s71, 1
    s_cselect_b32 s82, 1, 0
    s_bfe_u32 s68, s28, 0x2001a
    s_lshl_b32 s88, s68, 15
    s_bfe_u32 s70, s28, 0x10019
    s_bfe_u32 s68, s28, 0x10018
    s_lshl_b32 s68, s68, 10
    s_mul_i32 s69, s68, s82
    s_sub_u32 s68, s68, s69
    s_lshl_b32 s65, s70, 15
    s_add_u32 s64, s65, s68
    s_add_u32 s65, s65, 0x8000
    v_add_u32 v5, s69, v5
    v_add_u32 v6, s69, v6
    s_bfe_u32 s68, s26, 0x2001c
    s_add_u32 s85, s68, 3
    s_and_b32 s85, s85, 3
    s_lshl_b32 s85, s85, 8
    s_add_u32 s85, s85, s69
    v_add_u32 v251, s85, v248
    s_add_u32 s85, s68, 2
    s_and_b32 s85, s85, 3
    s_lshl_b32 s85, s85, 8
    s_add_u32 s85, s85, s69
    v_add_u32 v250, s85, v248
    s_add_u32 s85, s68, 1
    s_and_b32 s85, s85, 3
    s_lshl_b32 s85, s85, 8
    s_add_u32 s85, s85, s69
    v_add_u32 v249, s85, v248
    s_add_u32 s85, s68, 0
    s_and_b32 s85, s85, 3
    s_lshl_b32 s85, s85, 8
    s_add_u32 s85, s85, s69
    v_add_u32 v248, s85, v248
    v_add_u32 v252, s65, v248
    v_add_u32 v253, s65, v249
    v_add_u32 v254, s65, v250
    v_add_u32 v255, s65, v251
    v_add_u32 v7, s64, v5
    v_add_u32 v8, s64, v6
    s_and_b32 s68, s27, 0xff
    v_mov_b32 v22, s68
    s_bfe_u32 s66, s27, 0x80010
    s_cmp_lt_u32 s56, 4
    s_cbranch_scc1 L_sig0
    ds_write_b32 v21, v22
L_presig:
    s_mov_b32 m0, s61
    s_nop 0
    buffer_load_dwordx4 v3, s[40:43], s60 offen offset:3072  lds
    buffer_load_dwordx4 v1, s[32:35], s60 offen offset:1024  lds
    s_add_u32 m0, s61, 0x4000
    s_nop 0
    buffer_load_dwordx4 v4, s[40:43], s60 offen offset:3072  lds
    buffer_load_dwordx4 v2, s[32:35], s60 offen offset:1024  lds
    s_mov_b32 m0, s93
    v_add_u32 v23, 4, v23
    global_load_lds_dword v23, s[72:73]
    s_bitcmp1_b32 s23, 12
    s_cselect_b32 s50, s95, s94
    s_bfe_u32 s68, s23, 0xc0000
    s_add_u32 m0, s92, 32768
    s_lshl_b32 s68, s68, 12
    buffer_load_dwordx4 v1, s[48:51], s68 offen  lds
    s_add_u32 m0, m0, 0x4000
    s_nop 0
    buffer_load_dwordx4 v2, s[48:51], s68 offen  lds
    s_bitcmp1_b32 s23, 28
    s_cselect_b32 s50, s95, s94
    s_bfe_u32 s68, s23, 0xc0010
    s_add_u32 m0, s92, 33792
    s_lshl_b32 s68, s68, 12
    buffer_load_dwordx4 v1, s[48:51], s68 offen  lds
    s_add_u32 m0, m0, 0x4000
    s_nop 0
    buffer_load_dwordx4 v2, s[48:51], s68 offen  lds
    s_mov_b32 m0, s61
    s_nop 0
    buffer_load_dwordx4 v3, s[44:47], s60 offen offset:2048  lds
    buffer_load_dwordx4 v1, s[36:39], s60 offen  lds
    s_add_u32 m0, s61, 0x4000
    s_nop 0
    buffer_load_dwordx4 v4, s[44:47], s60 offen offset:2048  lds
    buffer_load_dwordx4 v2, s[36:39], s60 offen  lds
    s_mov_b32 m0, s93
    v_add_u32 v23, 4, v23
    global_load_lds_dword v23, s[72:73]
    s_add_u32 s60, s60, s97
    s_add_u32 s61, s61, 0x8000
    s_and_b32 s61, s61, 0x1ffff
    s_mov_b32 s91, 4
    s_cmp_eq_u32 s71, 0
    s_cbranch_scc1 L_hdone
    s_mov_b32 s89, 0
    s_branch L_sync
L_sig0:
    s_bfe_u32 s68, s27, 0x80008
    s_add_u32 s68, s68, s82
    s_lshl_b32 s68, s68, 2
    s_add_u32 s68, s68, L_cnt-L_pc-4
    v_mov_b32 v23, s68
    s_lshl_b32 s68, s56, 8
    s_add_u32 m0, s68, 161792
    s_min_u32 s70, s66, s63
L_pb1:
    v_cmp_ge_u32 vcc, s70, v10
    s_cbranch_vccnz L_pa1
L_head:
    ds_read_b128 v[24:27], v17 offset:0
    ds_read_b128 v[152:155], v7 offset:0
    ds_read_b128 v[28:31], v18 offset:0
    ds_read_b128 v[156:159], v8 offset:0
    ds_read_b128 v[32:35], v17 offset:256
    ds_read_b128 v[160:163], v7 offset:256
    ds_read_b128 v[36:39], v18 offset:256
    ds_read_b128 v[164:167], v8 offset:256
    ds_read_b128 v[40:43], v17 offset:16384
    ds_read_b128 v[168:171], v7 offset:16384
    ds_read_b128 v[44:47], v18 offset:16384
    ds_read_b128 v[172:175], v8 offset:16384
    ds_read_b128 v[48:51], v17 offset:16640
    ds_read_b128 v[176:179], v7 offset:16640
    s_add_u32 s68, s64, s88
    s_mul_i32 s64, s68, s82
    s_waitcnt lgkmcnt(12)
    v_mfma_f32_32x32x16_bf16 v[120:135], v[152:155], v[24:27], 0
    ds_read_b128 v[52:55], v18 offset:16640
    ds_read_b128 v[180:183], v8 offset:16640
    s_waitcnt lgkmcnt(12)
    v_mfma_f32_32x32x16_bf16 v[120:135], v[156:159], v[28:31], v[120:135]
    ds_read_b32 v10, v9
    v_add_u32 v7, s64, v5
    v_add_u32 v8, s64, v6
    s_add_u32 s64, s64, s88
    s_and_b32 s64, s64, 0x1ffff
    s_waitcnt lgkmcnt(11)
    v_mfma_f32_32x32x16_bf16 v[120:135], v[160:163], v[32:35], v[120:135]
    v_and_b32 v17, 31, v11
    v_lshlrev_b32 v17, 12, v17
    v_sub_u32 v17, s25, v17
    v_ashrrev_i32 v17, 31, v17
    v_and_b32 v17, 0xff800000, v17
    s_waitcnt lgkmcnt(9)
    v_mfma_f32_32x32x16_bf16 v[120:135], v[164:167], v[36:39], v[120:135]
    v_mov_b32 v18, L_cnt-L_pc+8
    s_bfe_u32 s68, s27, 0x80008
    v_mov_b32 v22, s68
    s_mov_b32 s66, s30
    s_waitcnt lgkmcnt(7)
    v_mfma_f32_32x32x16_bf16 v[120:135], v[168:171], v[40:43], v[120:135]
    s_waitcnt lgkmcnt(5)
    v_mfma_f32_32x32x16_bf16 v[120:135], v[172:175], v[44:47], v[120:135]
    s_waitcnt lgkmcnt(3)
    v_mfma_f32_32x32x16_bf16 v[120:135], v[176:179], v[48:51], v[120:135]
    s_waitcnt lgkmcnt(1)
    v_mfma_f32_32x32x16_bf16 v[120:135], v[180:183], v[52:55], v[120:135]
    s_cmp_lt_u32 s56, 4
    s_waitcnt lgkmcnt(0)
    s_cbranch_scc0 L_head2
    global_load_lds_dword v18, s[72:73]
    s_min_u32 s70, s66, s63
L_pb2:
    v_cmp_ge_u32 vcc, s70, v10
    s_cbranch_vccnz L_pa2
    ds_read_b128 v[152:155], v7 offset:0
    ds_read_b128 v[156:159], v8 offset:0
    ds_read_b128 v[160:163], v7 offset:256
    ds_read_b128 v[164:167], v8 offset:256
    ds_read_b128 v[168:171], v7 offset:16384
    ds_read_b128 v[172:175], v8 offset:16384
    ds_read_b128 v[176:179], v7 offset:16640
    ds_read_b128 v[180:183], v8 offset:16640
    v_add_u32 v7, s64, v5
    v_add_u32 v8, s64, v6
L_head2:
    s_lshr_b32 s66, s27, 24
    s_nop 7
    v_max3_f32 v15, v120, v121, v122
    v_max3_f32 v16, v123, v124, v125
    v_max3_f32 v15, v15, v126, v127
    v_max3_f32 v16, v16, v128, v129
    v_max3_f32 v15, v15, v130, v131
    v_max3_f32 v16, v16, v132, v133
    v_max3_f32 v15, v15, v134, v135
    v_max_f32 v15, v15, v16
    v_mov_b32 v16, v15
    ds_read_b32 v10, v9
    s_nop 0
    v_permlane32_swap_b32 v15, v16
    s_nop 1
    v_max_f32 v15, v15, v16
    v_fmamk_f32 v12, v15, 0xbe0293ee, v17
    v_fmamk_f32 v216, v120, 0x3e0293ee, v12
    v_fmamk_f32 v217, v121, 0x3e0293ee, v12
    v_fmamk_f32 v218, v122, 0x3e0293ee, v12
    v_fmamk_f32 v219, v123, 0x3e0293ee, v12
    v_fmamk_f32 v220, v124, 0x3e0293ee, v12
    v_fmamk_f32 v221, v125, 0x3e0293ee, v12
    v_fmamk_f32 v222, v126, 0x3e0293ee, v12
    v_fmamk_f32 v223, v127, 0x3e0293ee, v12
    v_fmamk_f32 v224, v128, 0x3e0293ee, v12
    v_fmamk_f32 v225, v129, 0x3e0293ee, v12
    v_fmamk_f32 v226, v130, 0x3e0293ee, v12
    v_fmamk_f32 v227, v131, 0x3e0293ee, v12
    v_fmamk_f32 v228, v132, 0x3e0293ee, v12
    v_fmamk_f32 v229, v133, 0x3e0293ee, v12
    v_fmamk_f32 v230, v134, 0x3e0293ee, v12
    v_fmamk_f32 v231, v135, 0x3e0293ee, v12
    v_exp_f32 v232, v216
    v_exp_f32 v233, v217
    v_exp_f32 v234, v218
    v_exp_f32 v235, v219
    v_exp_f32 v236, v220
    v_exp_f32 v237, v221
    v_exp_f32 v238, v222
    v_exp_f32 v239, v223
    v_add_f32 v14, v232, v233
    v_add_f32 v14, v14, v234
    v_add_f32 v14, v14, v235
    v_add_f32 v14, v14, v236
    v_add_f32 v14, v14, v237
    v_add_f32 v14, v14, v238
    v_cvt_pk_bf16_f32 v240, v232, v233
    v_cvt_pk_bf16_f32 v241, v234, v235
    v_cvt_pk_bf16_f32 v242, v236, v237
    s_cmp_lt_u32 s56, 4
    s_waitcnt lgkmcnt(0)
    s_cbranch_scc0 L_hlp_in
    s_min_u32 s70, s66, s63
L_pb3:
    v_cmp_ge_u32 vcc, s70, v10
    s_cbranch_vccnz L_pa3
    s_cmp_eq_u32 s82, 1
    s_cbranch_scc1 L_odd_m
.p2align 4
L_even_m:
    v_mfma_f32_32x32x16_bf16 v[120:135], v[152:155], v[24:27], 0
L_even_a:
    s_add_u32 s66, s66, s84
    ds_read_b64_tr_b16 v[184:185], v252 offset:1024
    ds_read_b64_tr_b16 v[186:187], v252 offset:9216
    v_exp_f32 v232, v224
    v_add_f32 v14, v14, v239
    v_cvt_pk_bf16_f32 v243, v238, v239
    v_mfma_f32_32x32x16_bf16 v[120:135], v[156:159], v[28:31], v[120:135]
    s_mov_b32 s79, 0
    ds_read_b64_tr_b16 v[188:189], v252 offset:1280
    ds_read_b64_tr_b16 v[190:191], v252 offset:9472
    v_exp_f32 v233, v225
    v_exp_f32 v234, v226
    v_mfma_f32_32x32x16_bf16 v[120:135], v[160:163], v[32:35], v[120:135]
    s_waitcnt lgkmcnt(4)
    ds_read_b64_tr_b16 v[192:193], v252 offset:1536
    ds_read_b64_tr_b16 v[194:195], v252 offset:9728
    v_exp_f32 v235, v227
    v_add_f32 v14, v14, v232
    v_add_f32 v14, v14, v233
    v_mfma_f32_32x32x16_bf16 v[120:135], v[164:167], v[36:39], v[120:135]
    s_sub_u32 s62, s62, 1
    ds_read_b64_tr_b16 v[196:197], v252 offset:1792
    ds_read_b64_tr_b16 v[198:199], v252 offset:9984
    v_exp_f32 v236, v228
    v_exp_f32 v237, v229
    v_mfma_f32_32x32x16_bf16 v[120:135], v[168:171], v[40:43], v[120:135]
    ds_read_b64_tr_b16 v[200:201], v252 offset:17408
    ds_read_b64_tr_b16 v[202:203], v252 offset:25600
    v_exp_f32 v238, v230
    v_add_f32 v14, v14, v234
    v_add_f32 v14, v14, v235
    v_mfma_f32_32x32x16_bf16 v[120:135], v[172:175], v[44:47], v[120:135]
    ds_read_b64_tr_b16 v[204:205], v252 offset:17664
    ds_read_b64_tr_b16 v[206:207], v252 offset:25856
    v_exp_f32 v239, v231
    v_add_f32 v14, v14, v236
    v_add_f32 v14, v14, v237
    v_mfma_f32_32x32x16_bf16 v[120:135], v[176:179], v[48:51], v[120:135]
    s_waitcnt lgkmcnt(4)
    ds_read_b64_tr_b16 v[208:209], v252 offset:17920
    ds_read_b64_tr_b16 v[210:211], v252 offset:26112
    v_add_f32 v14, v14, v238
    v_add_f32 v14, v14, v239
    v_cmp_lt_f32 vcc, s59, v14
    v_cvt_pk_bf16_f32 v244, v232, v233
    v_mfma_f32_32x32x16_bf16 v[120:135], v[180:183], v[52:55], v[120:135]
    s_cbranch_vccnz L_resc
L_ret0:
    ds_read_b64_tr_b16 v[212:213], v252 offset:18176
    ds_read_b64_tr_b16 v[214:215], v252 offset:26368
    v_add_f32 v13, v13, v14
    v_cvt_pk_bf16_f32 v245, v234, v235
    v_cvt_pk_bf16_f32 v246, v236, v237
    v_cvt_pk_bf16_f32 v247, v238, v239
    v_mfma_f32_32x32x16_bf16 v[56:71], v[184:187], v[240:243], v[56:71]
    s_min_u32 s67, s66, s63
    ds_read_b128 v[152:155], v7 offset:1024
    ds_read_b128 v[156:159], v8 offset:1024
    ds_read_b128 v[160:163], v7 offset:1280
    v_fmamk_f32 v216, v120, 0x3e0293ee, v12
    v_fmamk_f32 v217, v121, 0x3e0293ee, v12
    v_fmamk_f32 v218, v122, 0x3e0293ee, v12
    v_mfma_f32_32x32x16_bf16 v[72:87], v[188:191], v[240:243], v[72:87]
    s_bitcmp1_b32 s29, s62
    ds_read_b128 v[164:167], v8 offset:1280
    v_exp_f32 v232, v216
    v_fmamk_f32 v219, v123, 0x3e0293ee, v12
    v_fmamk_f32 v220, v124, 0x3e0293ee, v12
    v_fmamk_f32 v221, v125, 0x3e0293ee, v12
    v_mfma_f32_32x32x16_bf16 v[88:103], v[192:195], v[240:243], v[88:103]
    s_cselect_b32 s67, -1, s67
    ds_read_b128 v[168:171], v7 offset:17408
    ds_read_b32 v10, v9
    v_exp_f32 v233, v217
    v_fmamk_f32 v222, v126, 0x3e0293ee, v12
    v_fmamk_f32 v223, v127, 0x3e0293ee, v12
    v_fmamk_f32 v224, v128, 0x3e0293ee, v12
    v_mfma_f32_32x32x16_bf16 v[104:119], v[196:199], v[240:243], v[104:119]
    s_waitcnt lgkmcnt(5)
    ds_read_b128 v[172:175], v8 offset:17408
    v_exp_f32 v234, v218
    v_add_f32 v14, v232, v233
    v_fmamk_f32 v225, v129, 0x3e0293ee, v12
    v_fmamk_f32 v226, v130, 0x3e0293ee, v12
    v_mfma_f32_32x32x16_bf16 v[56:71], v[200:203], v[244:247], v[56:71]
    ds_read_b128 v[176:179], v7 offset:17664
    v_exp_f32 v235, v219
    v_add_f32 v14, v14, v234
    v_cvt_pk_bf16_f32 v240, v232, v233
    v_fmamk_f32 v227, v131, 0x3e0293ee, v12
    v_mfma_f32_32x32x16_bf16 v[72:87], v[204:207], v[244:247], v[72:87]
    ds_read_b128 v[180:183], v8 offset:17664
    v_exp_f32 v236, v220
    v_add_f32 v14, v14, v235
    v_cvt_pk_bf16_f32 v241, v234, v235
    v_fmamk_f32 v228, v132, 0x3e0293ee, v12
    v_mfma_f32_32x32x16_bf16 v[88:103], v[208:211], v[244:247], v[88:103]
    s_waitcnt lgkmcnt(3)
    v_exp_f32 v237, v221
    v_exp_f32 v238, v222
    v_add_f32 v14, v14, v236
    v_fmamk_f32 v229, v133, 0x3e0293ee, v12
    v_mfma_f32_32x32x16_bf16 v[104:119], v[212:215], v[244:247], v[104:119]
    v_exp_f32 v239, v223
    v_add_f32 v14, v14, v237
    v_cmp_ge_u32 vcc, s67, v10
    v_add_f32 v14, v14, v238
    v_cvt_pk_bf16_f32 v242, v236, v237
    v_fmamk_f32 v230, v134, 0x3e0293ee, v12
    v_fmamk_f32 v231, v135, 0x3e0293ee, v12
    s_cbranch_vccnz L_hnd_even
L_odd_m:
    v_mfma_f32_32x32x16_bf16 v[120:135], v[152:155], v[24:27], 0
L_odd_a:
    s_add_u32 s66, s66, s84
    ds_read_b64_tr_b16 v[184:185], v252 offset:0
    ds_read_b64_tr_b16 v[186:187], v252 offset:8192
    v_exp_f32 v232, v224
    v_add_f32 v14, v14, v239
    v_cvt_pk_bf16_f32 v243, v238, v239
    v_mfma_f32_32x32x16_bf16 v[120:135], v[156:159], v[28:31], v[120:135]
    s_mov_b32 s79, 1
    ds_read_b64_tr_b16 v[188:189], v252 offset:256
    ds_read_b64_tr_b16 v[190:191], v252 offset:8448
    v_exp_f32 v233, v225
    v_exp_f32 v234, v226
    v_mfma_f32_32x32x16_bf16 v[120:135], v[160:163], v[32:35], v[120:135]
    s_waitcnt lgkmcnt(4)
    ds_read_b64_tr_b16 v[192:193], v252 offset:512
    ds_read_b64_tr_b16 v[194:195], v252 offset:8704
    v_exp_f32 v235, v227
    v_add_f32 v14, v14, v232
    v_add_f32 v14, v14, v233
    v_add_u32 v23, 8, v23
    v_mfma_f32_32x32x16_bf16 v[120:135], v[164:167], v[36:39], v[120:135]
    s_sub_u32 s62, s62, 1
    ds_read_b64_tr_b16 v[196:197], v252 offset:768
    ds_read_b64_tr_b16 v[198:199], v252 offset:8960
    v_exp_f32 v236, v228
    v_exp_f32 v237, v229
    v_mfma_f32_32x32x16_bf16 v[120:135], v[168:171], v[40:43], v[120:135]
    s_add_u32 s65, s65, s88
    ds_read_b64_tr_b16 v[200:201], v252 offset:16384
    ds_read_b64_tr_b16 v[202:203], v252 offset:24576
    v_exp_f32 v238, v230
    v_add_f32 v14, v14, v234
    v_add_f32 v14, v14, v235
    v_mfma_f32_32x32x16_bf16 v[120:135], v[172:175], v[44:47], v[120:135]
    s_and_b32 s65, s65, 0x1ffff
    ds_read_b64_tr_b16 v[204:205], v252 offset:16640
    ds_read_b64_tr_b16 v[206:207], v252 offset:24832
    v_exp_f32 v239, v231
    v_add_f32 v14, v14, v236
    v_add_f32 v14, v14, v237
    v_mfma_f32_32x32x16_bf16 v[120:135], v[176:179], v[48:51], v[120:135]
    s_waitcnt lgkmcnt(4)
    ds_read_b64_tr_b16 v[208:209], v252 offset:16896
    ds_read_b64_tr_b16 v[210:211], v252 offset:25088
    v_add_f32 v14, v14, v238
    v_add_f32 v14, v14, v239
    v_cmp_lt_f32 vcc, s59, v14
    v_cvt_pk_bf16_f32 v244, v232, v233
    v_mfma_f32_32x32x16_bf16 v[120:135], v[180:183], v[52:55], v[120:135]
    s_cbranch_vccnz L_resc
L_ret1:
    ds_read_b64_tr_b16 v[212:213], v252 offset:17152
    ds_read_b64_tr_b16 v[214:215], v252 offset:25344
    v_add_f32 v13, v13, v14
    v_cvt_pk_bf16_f32 v245, v234, v235
    v_cvt_pk_bf16_f32 v246, v236, v237
    v_cvt_pk_bf16_f32 v247, v238, v239
    v_mfma_f32_32x32x16_bf16 v[56:71], v[184:187], v[240:243], v[56:71]
    s_min_u32 s67, s66, s63
    ds_read_b128 v[152:155], v7 offset:0
    ds_read_b128 v[156:159], v8 offset:0
    ds_read_b128 v[160:163], v7 offset:256
    v_fmamk_f32 v216, v120, 0x3e0293ee, v12
    v_fmamk_f32 v217, v121, 0x3e0293ee, v12
    v_fmamk_f32 v218, v122, 0x3e0293ee, v12
    v_mfma_f32_32x32x16_bf16 v[72:87], v[188:191], v[240:243], v[72:87]
    s_bitcmp1_b32 s29, s62
    ds_read_b128 v[164:167], v8 offset:256
    v_exp_f32 v232, v216
    v_fmamk_f32 v219, v123, 0x3e0293ee, v12
    v_fmamk_f32 v220, v124, 0x3e0293ee, v12
    v_fmamk_f32 v221, v125, 0x3e0293ee, v12
    v_add_u32 v252, s65, v248
    v_mfma_f32_32x32x16_bf16 v[88:103], v[192:195], v[240:243], v[88:103]
    s_cselect_b32 s67, -1, s67
    ds_read_b128 v[168:171], v7 offset:16384
    ds_read_b32 v10, v9
    v_exp_f32 v233, v217
    v_fmamk_f32 v222, v126, 0x3e0293ee, v12
    v_fmamk_f32 v223, v127, 0x3e0293ee, v12
    v_fmamk_f32 v224, v128, 0x3e0293ee, v12
    v_mfma_f32_32x32x16_bf16 v[104:119], v[196:199], v[240:243], v[104:119]
    s_waitcnt lgkmcnt(5)
    global_load_lds_dword v23, s[72:73]
    ds_read_b128 v[172:175], v8 offset:16384
    v_exp_f32 v234, v218
    v_add_f32 v14, v232, v233
    v_fmamk_f32 v225, v129, 0x3e0293ee, v12
    v_fmamk_f32 v226, v130, 0x3e0293ee, v12
    v_mfma_f32_32x32x16_bf16 v[56:71], v[200:203], v[244:247], v[56:71]
    s_add_u32 s64, s64, s88
    ds_read_b128 v[176:179], v7 offset:16640
    v_exp_f32 v235, v219
    v_add_f32 v14, v14, v234
    v_cvt_pk_bf16_f32 v240, v232, v233
    v_fmamk_f32 v227, v131, 0x3e0293ee, v12
    v_mfma_f32_32x32x16_bf16 v[72:87], v[204:207], v[244:247], v[72:87]
    s_and_b32 s64, s64, 0x1ffff
    ds_read_b128 v[180:183], v8 offset:16640
    v_exp_f32 v236, v220
    v_add_f32 v14, v14, v235
    v_cvt_pk_bf16_f32 v241, v234, v235
    v_fmamk_f32 v228, v132, 0x3e0293ee, v12
    v_mfma_f32_32x32x16_bf16 v[88:103], v[208:211], v[244:247], v[88:103]
    s_waitcnt lgkmcnt(3)
    v_exp_f32 v237, v221
    v_exp_f32 v238, v222
    v_add_f32 v14, v14, v236
    v_fmamk_f32 v229, v133, 0x3e0293ee, v12
    v_add_u32 v7, s64, v5
    v_mfma_f32_32x32x16_bf16 v[104:119], v[212:215], v[244:247], v[104:119]
    v_exp_f32 v239, v223
    v_add_f32 v14, v14, v237
    v_cmp_ge_u32 vcc, s67, v10
    v_add_f32 v14, v14, v238
    v_cvt_pk_bf16_f32 v242, v236, v237
    v_fmamk_f32 v230, v134, 0x3e0293ee, v12
    v_fmamk_f32 v231, v135, 0x3e0293ee, v12
    v_add_u32 v8, s64, v6
    s_cbranch_vccz L_even_m
    s_min_u32 s70, s66, s63
L_pb4:
    v_cmp_ge_u32 vcc, s70, v10
    s_cbranch_vccnz L_pa4
    s_cmp_le_u32 s62, 1
    s_cbranch_scc1 L_ho1
    s_cmp_eq_u32 s82, 0
    s_cbranch_scc0 L_odd_m
    s_branch L_even_m
L_ho1:
    s_cmp_eq_u32 s82, 0
    s_cbranch_scc0 L_ho2
    v_mov_b32 v253, v252
    v_add_u32 v252, 0x400, v252
    s_branch L_last
L_hnd_even:
    s_min_u32 s70, s66, s63
L_pb5:
    v_cmp_ge_u32 vcc, s70, v10
    s_cbranch_vccnz L_pa5
    s_cmp_gt_u32 s62, 1
    s_cbranch_scc1 L_odd_m
    v_add_u32 v248, 0x400, v248
L_ho2:
    s_add_u32 s65, s65, s88
    s_and_b32 s65, s65, 0x1ffff
    v_add_u32 v253, s65, v248
    s_branch L_last
L_hlp_in:
    ds_write_b32 v21, v22
    s_mov_b32 s89, 1
    s_branch L_sync
L_sr1:
    ds_read_b128 v[152:155], v7 offset:0
    ds_read_b128 v[156:159], v8 offset:0
    ds_read_b128 v[160:163], v7 offset:256
    ds_read_b128 v[164:167], v8 offset:256
    ds_read_b128 v[168:171], v7 offset:16384
    ds_read_b128 v[172:175], v8 offset:16384
    ds_read_b128 v[176:179], v7 offset:16640
    ds_read_b128 v[180:183], v8 offset:16640
    v_add_u32 v7, s64, v5
    v_add_u32 v8, s64, v6
    s_waitcnt lgkmcnt(4)
    s_branch L_hnd_hlp
L_hlp_m:
    v_mfma_f32_32x32x16_bf16 v[120:135], v[152:155], v[24:27], 0
L_hlp_a:
    s_add_u32 s66, s66, s84
    ds_read_b64_tr_b16 v[184:185], v252 offset:0
    ds_read_b64_tr_b16 v[186:187], v252 offset:8192
    v_exp_f32 v232, v224
    v_add_f32 v14, v14, v239
    v_cvt_pk_bf16_f32 v243, v238, v239
    v_mfma_f32_32x32x16_bf16 v[120:135], v[156:159], v[28:31], v[120:135]
    s_mov_b32 s79, 2
    ds_read_b64_tr_b16 v[188:189], v253 offset:0
    ds_read_b64_tr_b16 v[190:191], v253 offset:8192
    v_exp_f32 v233, v225
    v_exp_f32 v234, v226
    v_add_u32 v22, s84, v22
    v_mfma_f32_32x32x16_bf16 v[120:135], v[160:163], v[32:35], v[120:135]
    s_waitcnt lgkmcnt(4)
    ds_read_b64_tr_b16 v[192:193], v254 offset:0
    ds_read_b64_tr_b16 v[194:195], v254 offset:8192
    v_exp_f32 v235, v227
    v_add_f32 v14, v14, v232
    v_add_f32 v14, v14, v233
    v_mfma_f32_32x32x16_bf16 v[120:135], v[164:167], v[36:39], v[120:135]
    s_sub_u32 s62, s62, 1
    s_mov_b32 s89, 2
    ds_read_b64_tr_b16 v[196:197], v255 offset:0
    ds_read_b64_tr_b16 v[198:199], v255 offset:8192
    v_exp_f32 v236, v228
    v_exp_f32 v237, v229
    v_mfma_f32_32x32x16_bf16 v[120:135], v[168:171], v[40:43], v[120:135]
    s_add_u32 s65, s65, s88
    ds_read_b64_tr_b16 v[200:201], v252 offset:16384
    ds_read_b64_tr_b16 v[202:203], v252 offset:24576
    v_exp_f32 v238, v230
    v_add_f32 v14, v14, v234
    v_add_f32 v14, v14, v235
    v_mfma_f32_32x32x16_bf16 v[120:135], v[172:175], v[44:47], v[120:135]
    s_and_b32 s65, s65, 0x1ffff
    ds_read_b64_tr_b16 v[204:205], v253 offset:16384
    ds_read_b64_tr_b16 v[206:207], v253 offset:24576
    v_exp_f32 v239, v231
    v_add_f32 v14, v14, v236
    v_add_f32 v14, v14, v237
    v_mfma_f32_32x32x16_bf16 v[120:135], v[176:179], v[48:51], v[120:135]
    s_waitcnt lgkmcnt(4)
    ds_read_b64_tr_b16 v[208:209], v254 offset:16384
    ds_read_b64_tr_b16 v[210:211], v254 offset:24576
    v_add_f32 v14, v14, v238
    v_add_f32 v14, v14, v239
    v_cmp_lt_f32 vcc, s59, v14
    v_cvt_pk_bf16_f32 v244, v232, v233
    v_mfma_f32_32x32x16_bf16 v[120:135], v[180:183], v[52:55], v[120:135]
    s_cbranch_vccnz L_resc
L_ret2:
    ds_read_b64_tr_b16 v[212:213], v255 offset:16384
    ds_read_b64_tr_b16 v[214:215], v255 offset:24576
    ds_write_b32 v21, v22
    v_add_f32 v13, v13, v14
    v_cvt_pk_bf16_f32 v245, v234, v235
    v_cvt_pk_bf16_f32 v246, v236, v237
    v_cvt_pk_bf16_f32 v247, v238, v239
    v_mfma_f32_32x32x16_bf16 v[56:71], v[184:187], v[240:243], v[56:71]
    s_branch L_sync
L_sr2:
    ds_read_b128 v[152:155], v7 offset:0
    ds_read_b128 v[156:159], v8 offset:0
    ds_read_b128 v[160:163], v7 offset:256
    v_fmamk_f32 v216, v120, 0x3e0293ee, v12
    v_fmamk_f32 v217, v121, 0x3e0293ee, v12
    v_fmamk_f32 v218, v122, 0x3e0293ee, v12
    v_mfma_f32_32x32x16_bf16 v[72:87], v[188:191], v[240:243], v[72:87]
    ds_read_b128 v[164:167], v8 offset:256
    v_exp_f32 v232, v216
    v_fmamk_f32 v219, v123, 0x3e0293ee, v12
    v_fmamk_f32 v220, v124, 0x3e0293ee, v12
    v_fmamk_f32 v221, v125, 0x3e0293ee, v12
    v_add_u32 v252, s65, v248
    v_mfma_f32_32x32x16_bf16 v[88:103], v[192:195], v[240:243], v[88:103]
    ds_read_b128 v[168:171], v7 offset:16384
    v_exp_f32 v233, v217
    v_fmamk_f32 v222, v126, 0x3e0293ee, v12
    v_fmamk_f32 v223, v127, 0x3e0293ee, v12
    v_fmamk_f32 v224, v128, 0x3e0293ee, v12
    v_mfma_f32_32x32x16_bf16 v[104:119], v[196:199], v[240:243], v[104:119]
    s_waitcnt lgkmcnt(5)
    ds_read_b128 v[172:175], v8 offset:16384
    v_exp_f32 v234, v218
    v_add_f32 v14, v232, v233
    v_fmamk_f32 v225, v129, 0x3e0293ee, v12
    v_fmamk_f32 v226, v130, 0x3e0293ee, v12
    v_add_u32 v253, s65, v249
    v_mfma_f32_32x32x16_bf16 v[56:71], v[200:203], v[244:247], v[56:71]
    s_add_u32 s64, s64, s88
    ds_read_b128 v[176:179], v7 offset:16640
    v_exp_f32 v235, v219
    v_add_f32 v14, v14, v234
    v_cvt_pk_bf16_f32 v240, v232, v233
    v_fmamk_f32 v227, v131, 0x3e0293ee, v12
    v_add_u32 v254, s65, v250
    v_mfma_f32_32x32x16_bf16 v[72:87], v[204:207], v[244:247], v[72:87]
    s_and_b32 s64, s64, 0x1ffff
    ds_read_b128 v[180:183], v8 offset:16640
    v_exp_f32 v236, v220
    v_add_f32 v14, v14, v235
    v_cvt_pk_bf16_f32 v241, v234, v235
    v_fmamk_f32 v228, v132, 0x3e0293ee, v12
    v_add_u32 v255, s65, v251
    v_mfma_f32_32x32x16_bf16 v[88:103], v[208:211], v[244:247], v[88:103]
    s_waitcnt lgkmcnt(4)
    v_exp_f32 v237, v221
    v_exp_f32 v238, v222
    v_add_f32 v14, v14, v236
    v_fmamk_f32 v229, v133, 0x3e0293ee, v12
    v_add_u32 v7, s64, v5
    v_mfma_f32_32x32x16_bf16 v[104:119], v[212:215], v[244:247], v[104:119]
    v_exp_f32 v239, v223
    v_add_f32 v14, v14, v237
    v_add_f32 v14, v14, v238
    v_cvt_pk_bf16_f32 v242, v236, v237
    v_fmamk_f32 v230, v134, 0x3e0293ee, v12
    v_fmamk_f32 v231, v135, 0x3e0293ee, v12
    v_add_u32 v8, s64, v6
L_hnd_hlp:
    s_cmp_gt_u32 s62, 1
    s_cbranch_scc1 L_hlp_m
    s_cmp_eq_u32 s62, 0
    s_cbranch_scc1 L_tail
    v_mfma_f32_32x32x16_bf16 v[120:135], v[152:155], v[24:27], v[136:151]
    s_branch L_hlp_a
L_tail:
    s_setprio 0
    ds_read_b64_tr_b16 v[184:185], v252 offset:0
    ds_read_b64_tr_b16 v[186:187], v252 offset:8192
    ds_read_b64_tr_b16 v[188:189], v253 offset:0
    ds_read_b64_tr_b16 v[190:191], v253 offset:8192
    ds_read_b64_tr_b16 v[192:193], v254 offset:0
    ds_read_b64_tr_b16 v[194:195], v254 offset:8192
    ds_read_b64_tr_b16 v[196:197], v255 offset:0
    ds_read_b64_tr_b16 v[198:199], v255 offset:8192
    ds_read_b64_tr_b16 v[200:201], v252 offset:16384
    ds_read_b64_tr_b16 v[202:203], v252 offset:24576
    ds_read_b64_tr_b16 v[204:205], v253 offset:16384
    ds_read_b64_tr_b16 v[206:207], v253 offset:24576
    v_exp_f32 v232, v224
    v_add_f32 v14, v14, v239
    v_cvt_pk_bf16_f32 v243, v238, v239
    v_exp_f32 v233, v225
    v_exp_f32 v234, v226
    v_exp_f32 v235, v227
    v_exp_f32 v236, v228
    v_exp_f32 v237, v229
    v_exp_f32 v238, v230
    v_exp_f32 v239, v231
    v_mov_b32 v22, 16384
    ds_read_b64_tr_b16 v[208:209], v254 offset:16384
    ds_read_b64_tr_b16 v[210:211], v254 offset:24576
    ds_read_b64_tr_b16 v[212:213], v255 offset:16384
    ds_read_b64_tr_b16 v[214:215], v255 offset:24576
    ds_write_b32 v21, v22
    v_add_f32 v14, v14, v232
    v_add_f32 v14, v14, v233
    v_add_f32 v14, v14, v234
    v_add_f32 v14, v14, v235
    v_add_f32 v14, v14, v236
    v_add_f32 v14, v14, v237
    v_add_f32 v14, v14, v238
    v_add_f32 v14, v14, v239
    v_cmp_lt_f32 vcc, s59, v14
    v_cvt_pk_bf16_f32 v244, v232, v233
    s_mov_b32 s79, 3
    s_cbranch_vccnz L_resc
L_ret3:
    v_cvt_pk_bf16_f32 v245, v234, v235
    v_cvt_pk_bf16_f32 v246, v236, v237
    v_cvt_pk_bf16_f32 v247, v238, v239
    v_add_f32 v13, v13, v14
    s_waitcnt lgkmcnt(0)
    v_mfma_f32_32x32x16_bf16 v[104:119], v[196:199], v[240:243], v[104:119]
    v_mov_b32 v15, v13
    s_nop 1
    v_permlane32_swap_b32 v13, v15
    s_nop 1
    v_add_f32 v13, v13, v15
    v_lshlrev_b32 v7, 4, v11
    v_lshlrev_b32 v5, 3, v11
    s_lshl_b32 s68, s56, 9
    v_mfma_f32_32x32x16_bf16 v[104:119], v[212:215], v[244:247], v[104:119]
    s_add_u32 s68, s68, 153600
    v_add_u32 v248, s68, v5
    v_add_u32 v250, s81, v7
    ds_write_b64 v248, v[12:13]
    s_lshr_b32 s68, s29, 24
    s_lshl_b32 s68, s68, 9
    s_add_u32 s68, s68, 155648
    v_add_u32 v232, s68, v5
    v_mfma_f32_32x32x16_bf16 v[88:103], v[192:195], v[240:243], v[88:103]
    s_and_b32 s68, s29, 0xffffff
    v_add_u32 v236, s68, v7
    s_lshr_b32 s68, s30, 24
    s_lshl_b32 s68, s68, 9
    s_add_u32 s68, s68, 155648
    v_add_u32 v233, s68, v5
    s_and_b32 s68, s30, 0xffffff
    v_add_u32 v237, s68, v7
    v_mfma_f32_32x32x16_bf16 v[88:103], v[208:211], v[244:247], v[88:103]
    s_lshr_b32 s68, s31, 24
    s_lshl_b32 s68, s68, 9
    s_add_u32 s68, s68, 155648
    v_add_u32 v234, s68, v5
    s_and_b32 s68, s31, 0xffffff
    v_add_u32 v238, s68, v7
    s_lshr_b32 s68, s26, 30
    s_lshl2_add_u32 s68, s68, 157696
    v_mfma_f32_32x32x16_bf16 v[72:87], v[188:191], v[240:243], v[72:87]
    v_mov_b32 v249, s68
    v_mov_b32 v251, 1
    v_and_b32 v15, 31, v11
    v_lshrrev_b32 v16, 2, v11
    v_and_b32 v17, 7, v11
    v_lshrrev_b32 v18, 3, v11
    v_lshlrev_b32 v15, 7, v15
    v_xor_b32 v16, v16, v11
    v_mfma_f32_32x32x16_bf16 v[72:87], v[204:207], v[244:247], v[72:87]
    v_xor_b32 v254, v17, v18
    v_and_b32 v16, 8, v16
    v_lshlrev_b32 v17, 4, v17
    v_add3_u32 v15, v15, v16, s81
    v_lshlrev_b32 v254, 4, v254
    v_lshlrev_b32 v16, 7, v18
    v_add_u32 v136, v15, v17
    v_lshl_add_u32 v6, v18, 12, v17
    v_mfma_f32_32x32x16_bf16 v[56:71], v[184:187], v[240:243], v[56:71]
    v_add3_u32 v254, v254, v16, s81
    v_xor_b32 v137, 16, v136
    v_xor_b32 v138, 32, v136
    v_xor_b32 v139, 48, v136
    v_xor_b32 v140, 64, v136
    v_xor_b32 v141, 80, v136
    v_xor_b32 v142, 96, v136
    v_xor_b32 v143, 112, v136
    v_mfma_f32_32x32x16_bf16 v[56:71], v[200:203], v[244:247], v[56:71]
    v_add_u32 v8, 0x800, v254
    ds_read_b32 v14, v0
    s_cmp_gt_u32 s91, s58
    s_cbranch_scc1 L_hfree
    s_branch L_hdone
L_solo:
    v_rcp_f32 v144, v13
    s_mov_b32 s85, 0
    s_mov_b32 s86, 0x8000
    s_mov_b32 s87, 0x10000
    s_mov_b32 s69, 0x18000
    s_nop 4
    v_pk_mul_f32 v[56:57], v[56:57], v[144:145] op_sel_hi:[1,0]
    v_pk_mul_f32 v[58:59], v[58:59], v[144:145] op_sel_hi:[1,0]
    v_pk_mul_f32 v[60:61], v[60:61], v[144:145] op_sel_hi:[1,0]
    v_pk_mul_f32 v[62:63], v[62:63], v[144:145] op_sel_hi:[1,0]
    v_pk_mul_f32 v[64:65], v[64:65], v[144:145] op_sel_hi:[1,0]
    v_pk_mul_f32 v[66:67], v[66:67], v[144:145] op_sel_hi:[1,0]
    v_pk_mul_f32 v[68:69], v[68:69], v[144:145] op_sel_hi:[1,0]
    v_pk_mul_f32 v[70:71], v[70:71], v[144:145] op_sel_hi:[1,0]
    v_cvt_pk_bf16_f32 v184, v56, v57
    v_cvt_pk_bf16_f32 v185, v58, v59
    v_cvt_pk_bf16_f32 v186, v60, v61
    v_cvt_pk_bf16_f32 v187, v62, v63
    v_cvt_pk_bf16_f32 v188, v64, v65
    v_cvt_pk_bf16_f32 v189, v66, v67
    v_cvt_pk_bf16_f32 v190, v68, v69
    v_cvt_pk_bf16_f32 v191, v70, v71
    s_branch L_tail3
L_last:
    v_mfma_f32_32x32x16_bf16 v[120:135], v[152:155], v[24:27], v[136:151]
    s_add_u32 s66, s66, s84
    s_lshl2_add_u32 s68, s63, L_cnt-L_pc
    ds_read_b64_tr_b16 v[184:185], v252 offset:0
    ds_read_b64_tr_b16 v[186:187], v252 offset:8192
    v_exp_f32 v232, v224
    v_add_f32 v14, v14, v239
    v_cvt_pk_bf16_f32 v243, v238, v239
    v_mfma_f32_32x32x16_bf16 v[120:135], v[156:159], v[28:31], v[120:135]
    s_mov_b32 s79, 4
    ds_read_b64_tr_b16 v[188:189], v252 offset:256
    ds_read_b64_tr_b16 v[190:191], v252 offset:8448
    v_exp_f32 v233, v225
    v_exp_f32 v234, v226
    v_mov_b32 v23, s68
    v_mfma_f32_32x32x16_bf16 v[120:135], v[160:163], v[32:35], v[120:135]
    s_waitcnt lgkmcnt(4)
    global_load_lds_dword v23, s[72:73]
    ds_read_b64_tr_b16 v[192:193], v252 offset:512
    ds_read_b64_tr_b16 v[194:195], v252 offset:8704
    v_exp_f32 v235, v227
    v_add_f32 v14, v14, v232
    v_add_f32 v14, v14, v233
    v_mfma_f32_32x32x16_bf16 v[120:135], v[164:167], v[36:39], v[120:135]
    s_mov_b32 s85, 0
    ds_read_b64_tr_b16 v[196:197], v252 offset:768
    ds_read_b64_tr_b16 v[198:199], v252 offset:8960
    ds_read_b32 v10, v9
    v_exp_f32 v236, v228
    v_exp_f32 v237, v229
    v_mfma_f32_32x32x16_bf16 v[120:135], v[168:171], v[40:43], v[120:135]
    s_mov_b32 s86, 0x8000
    ds_read_b64_tr_b16 v[200:201], v252 offset:16384
    ds_read_b64_tr_b16 v[202:203], v252 offset:24576
    v_exp_f32 v238, v230
    v_add_f32 v14, v14, v234
    v_add_f32 v14, v14, v235
    v_mfma_f32_32x32x16_bf16 v[120:135], v[172:175], v[44:47], v[120:135]
    s_mov_b32 s87, 0x10000
    ds_read_b64_tr_b16 v[204:205], v252 offset:16640
    ds_read_b64_tr_b16 v[206:207], v252 offset:24832
    v_exp_f32 v239, v231
    v_add_f32 v14, v14, v236
    v_add_f32 v14, v14, v237
    v_mfma_f32_32x32x16_bf16 v[120:135], v[176:179], v[48:51], v[120:135]
    s_waitcnt lgkmcnt(4)
    ds_read_b64_tr_b16 v[208:209], v252 offset:16896
    ds_read_b64_tr_b16 v[210:211], v252 offset:25088
    v_add_f32 v14, v14, v238
    v_add_f32 v14, v14, v239
    v_cmp_lt_f32 vcc, s59, v14
    v_cvt_pk_bf16_f32 v244, v232, v233
    v_mfma_f32_32x32x16_bf16 v[120:135], v[180:183], v[52:55], v[120:135]
    s_cbranch_vccnz L_resc
L_ret4:
    ds_read_b64_tr_b16 v[212:213], v252 offset:17152
    ds_read_b64_tr_b16 v[214:215], v252 offset:25344
    v_add_f32 v13, v13, v14
    v_cvt_pk_bf16_f32 v245, v234, v235
    v_cvt_pk_bf16_f32 v246, v236, v237
    v_cvt_pk_bf16_f32 v247, v238, v239
    v_mfma_f32_32x32x16_bf16 v[56:71], v[184:187], v[240:243], v[56:71]
    s_min_u32 s70, s66, s63
L_pb6:
    v_cmp_ge_u32 vcc, s70, v10
    s_cbranch_vccnz L_pa6
    s_bitcmp1_b32 s28, 31
    s_cbranch_scc1 L_lasts
    ds_read_b64_tr_b16 v[152:153], v253 offset:0
    ds_read_b64_tr_b16 v[154:155], v253 offset:8192
    ds_read_b64_tr_b16 v[168:169], v253 offset:16384
    v_fmamk_f32 v216, v120, 0x3e0293ee, v12
    v_fmamk_f32 v217, v121, 0x3e0293ee, v12
    v_fmamk_f32 v218, v122, 0x3e0293ee, v12
    v_fmamk_f32 v219, v123, 0x3e0293ee, v12
    v_mfma_f32_32x32x16_bf16 v[72:87], v[188:191], v[240:243], v[72:87]
    s_mov_b32 s69, 0x18000
    ds_read_b64_tr_b16 v[170:171], v253 offset:24576
    ds_read_b64_tr_b16 v[156:157], v253 offset:256
    v_exp_f32 v232, v216
    v_exp_f32 v233, v217
    v_fmamk_f32 v220, v124, 0x3e0293ee, v12
    v_fmamk_f32 v221, v125, 0x3e0293ee, v12
    v_fmamk_f32 v222, v126, 0x3e0293ee, v12
    v_fmamk_f32 v223, v127, 0x3e0293ee, v12
    v_mfma_f32_32x32x16_bf16 v[88:103], v[192:195], v[240:243], v[88:103]
    s_mov_b32 s79, 5
    ds_read_b64_tr_b16 v[158:159], v253 offset:8448
    ds_read_b64_tr_b16 v[172:173], v253 offset:16640
    v_exp_f32 v234, v218
    v_exp_f32 v235, v219
    v_add_f32 v14, v232, v233
    v_fmamk_f32 v224, v128, 0x3e0293ee, v12
    v_fmamk_f32 v225, v129, 0x3e0293ee, v12
    v_fmamk_f32 v226, v130, 0x3e0293ee, v12
    v_mfma_f32_32x32x16_bf16 v[104:119], v[196:199], v[240:243], v[104:119]
    s_waitcnt lgkmcnt(7)
    ds_read_b64_tr_b16 v[174:175], v253 offset:24832
    ds_read_b64_tr_b16 v[160:161], v253 offset:512
    ds_read_b64_tr_b16 v[162:163], v253 offset:8704
    v_exp_f32 v236, v220
    v_exp_f32 v237, v221
    v_add_f32 v14, v14, v234
    v_add_f32 v14, v14, v235
    v_fmamk_f32 v227, v131, 0x3e0293ee, v12
    v_fmamk_f32 v228, v132, 0x3e0293ee, v12
    v_mfma_f32_32x32x16_bf16 v[56:71], v[200:203], v[244:247], v[56:71]
    ds_read_b64_tr_b16 v[176:177], v253 offset:16896
    ds_read_b64_tr_b16 v[178:179], v253 offset:25088
    v_exp_f32 v238, v222
    v_exp_f32 v239, v223
    v_cvt_pk_bf16_f32 v240, v232, v233
    v_cvt_pk_bf16_f32 v241, v234, v235
    v_add_f32 v14, v14, v236
    v_add_f32 v14, v14, v237
    v_fmamk_f32 v229, v133, 0x3e0293ee, v12
    v_mfma_f32_32x32x16_bf16 v[72:87], v[204:207], v[244:247], v[72:87]
    ds_read_b64_tr_b16 v[164:165], v253 offset:768
    ds_read_b64_tr_b16 v[166:167], v253 offset:8960
    v_exp_f32 v232, v224
    v_exp_f32 v233, v225
    v_cvt_pk_bf16_f32 v242, v236, v237
    v_add_f32 v14, v14, v238
    v_add_f32 v14, v14, v239
    v_cvt_pk_bf16_f32 v243, v238, v239
    v_fmamk_f32 v230, v134, 0x3e0293ee, v12
    v_fmamk_f32 v231, v135, 0x3e0293ee, v12
    v_mfma_f32_32x32x16_bf16 v[88:103], v[208:211], v[244:247], v[88:103]
    ds_read_b64_tr_b16 v[180:181], v253 offset:17152
    ds_read_b64_tr_b16 v[182:183], v253 offset:25344
    v_exp_f32 v234, v226
    v_exp_f32 v235, v227
    v_exp_f32 v236, v228
    v_add_f32 v14, v14, v232
    v_add_f32 v14, v14, v233
    v_mov_b32 v23, L_cnt-L_pc+124
    v_mfma_f32_32x32x16_bf16 v[104:119], v[212:215], v[244:247], v[104:119]
    v_exp_f32 v237, v229
    v_exp_f32 v238, v230
    v_exp_f32 v239, v231
    v_add_f32 v14, v14, v234
    v_add_f32 v14, v14, v235
    v_add_f32 v14, v14, v236
    v_add_f32 v14, v14, v237
    v_add_f32 v14, v14, v238
    v_add_f32 v14, v14, v239
    v_cmp_lt_f32 vcc, s59, v14
    v_cvt_pk_bf16_f32 v244, v232, v233
    v_cvt_pk_bf16_f32 v245, v234, v235
    v_cvt_pk_bf16_f32 v246, v236, v237
    v_cvt_pk_bf16_f32 v247, v238, v239
    s_cbranch_vccnz L_resc
L_ret5:
    v_add_f32 v13, v13, v14
    s_waitcnt lgkmcnt(0)
    v_mfma_f32_32x32x16_bf16 v[56:71], v[152:155], v[240:243], v[56:71]
    global_load_lds_dword v23, s[72:73]
    v_mov_b32 v15, v13
    s_nop 1
    v_permlane32_swap_b32 v13, v15
    s_nop 1
    v_add_f32 v13, v13, v15
    v_rcp_f32 v144, v13
    v_mfma_f32_32x32x16_bf16 v[56:71], v[168:171], v[244:247], v[56:71]
    v_and_b32 v15, 31, v11
    v_lshrrev_b32 v16, 2, v11
    v_and_b32 v17, 7, v11
    v_lshrrev_b32 v18, 3, v11
    v_lshlrev_b32 v15, 7, v15
    v_xor_b32 v16, v16, v11
    v_xor_b32 v254, v17, v18
    v_and_b32 v16, 8, v16
    v_mfma_f32_32x32x16_bf16 v[72:87], v[156:159], v[240:243], v[72:87]
    v_lshlrev_b32 v17, 4, v17
    v_add3_u32 v15, v15, v16, s81
    v_lshlrev_b32 v254, 4, v254
    v_lshlrev_b32 v16, 7, v18
    v_add_u32 v136, v15, v17
    v_lshl_add_u32 v6, v18, 12, v17
    v_add3_u32 v254, v254, v16, s81
    v_xor_b32 v137, 16, v136
    v_mfma_f32_32x32x16_bf16 v[72:87], v[172:175], v[244:247], v[72:87]
    v_xor_b32 v138, 32, v136
    v_xor_b32 v139, 48, v136
    v_xor_b32 v140, 64, v136
    v_xor_b32 v141, 80, v136
    v_xor_b32 v142, 96, v136
    v_xor_b32 v143, 112, v136
    v_add_u32 v8, 0x800, v254
    v_mfma_f32_32x32x16_bf16 v[88:103], v[160:163], v[240:243], v[88:103]
    v_mul_f32 v56, v56, v144
    v_mul_f32 v57, v57, v144
    v_mul_f32 v58, v58, v144
    v_mul_f32 v59, v59, v144
    v_mul_f32 v60, v60, v144
    v_mul_f32 v61, v61, v144
    v_mfma_f32_32x32x16_bf16 v[88:103], v[176:179], v[244:247], v[88:103]
    v_mul_f32 v62, v62, v144
    v_mul_f32 v63, v63, v144
    v_mul_f32 v64, v64, v144
    v_mul_f32 v65, v65, v144
    v_mul_f32 v66, v66, v144
    v_mul_f32 v67, v67, v144
    v_mfma_f32_32x32x16_bf16 v[104:119], v[164:167], v[240:243], v[104:119]
    v_mul_f32 v68, v68, v144
    v_mul_f32 v69, v69, v144
    v_mul_f32 v70, v70, v144
    v_mul_f32 v71, v71, v144
    v_cvt_pk_bf16_f32 v184, v56, v57
    v_cvt_pk_bf16_f32 v185, v58, v59
    v_mfma_f32_32x32x16_bf16 v[104:119], v[180:183], v[244:247], v[104:119]
    v_cvt_pk_bf16_f32 v186, v60, v61
    v_cvt_pk_bf16_f32 v187, v62, v63
    v_cvt_pk_bf16_f32 v188, v64, v65
    v_cvt_pk_bf16_f32 v189, v66, v67
    v_cvt_pk_bf16_f32 v190, v68, v69
    v_cvt_pk_bf16_f32 v191, v70, v71
L_tail3:
    ds_write_b64 v136, v[184:185]
    v_pk_mul_f32 v[72:73], v[72:73], v[144:145] op_sel_hi:[1,0]
    v_pk_mul_f32 v[74:75], v[74:75], v[144:145] op_sel_hi:[1,0]
    v_pk_mul_f32 v[76:77], v[76:77], v[144:145] op_sel_hi:[1,0]
    v_pk_mul_f32 v[78:79], v[78:79], v[144:145] op_sel_hi:[1,0]
    ds_write_b64 v137, v[186:187]
    v_pk_mul_f32 v[80:81], v[80:81], v[144:145] op_sel_hi:[1,0]
    v_pk_mul_f32 v[82:83], v[82:83], v[144:145] op_sel_hi:[1,0]
    v_pk_mul_f32 v[84:85], v[84:85], v[144:145] op_sel_hi:[1,0]
    v_pk_mul_f32 v[86:87], v[86:87], v[144:145] op_sel_hi:[1,0]
    ds_write_b64 v138, v[188:189]
    v_cvt_pk_bf16_f32 v192, v72, v73
    v_cvt_pk_bf16_f32 v193, v74, v75
    v_cvt_pk_bf16_f32 v194, v76, v77
    v_cvt_pk_bf16_f32 v195, v78, v79
    ds_write_b64 v139, v[190:191]
    v_cvt_pk_bf16_f32 v196, v80, v81
    v_cvt_pk_bf16_f32 v197, v82, v83
    v_cvt_pk_bf16_f32 v198, v84, v85
    v_cvt_pk_bf16_f32 v199, v86, v87
    ds_write_b64 v140, v[192:193]
    v_pk_mul_f32 v[88:89], v[88:89], v[144:145] op_sel_hi:[1,0]
    v_pk_mul_f32 v[90:91], v[90:91], v[144:145] op_sel_hi:[1,0]
    ds_write_b64 v141, v[194:195]
    v_pk_mul_f32 v[92:93], v[92:93], v[144:145] op_sel_hi:[1,0]
    v_pk_mul_f32 v[94:95], v[94:95], v[144:145] op_sel_hi:[1,0]
    ds_write_b64 v142, v[196:197]
    v_pk_mul_f32 v[96:97], v[96:97], v[144:145] op_sel_hi:[1,0]
    v_pk_mul_f32 v[98:99], v[98:99], v[144:145] op_sel_hi:[1,0]
    ds_write_b64 v143, v[198:199]
    v_pk_mul_f32 v[100:101], v[100:101], v[144:145] op_sel_hi:[1,0]
    v_pk_mul_f32 v[102:103], v[102:103], v[144:145] op_sel_hi:[1,0]
    ds_read_b128 v[152:155], v254
    v_cvt_pk_bf16_f32 v200, v88, v89
    v_cvt_pk_bf16_f32 v201, v90, v91
    ds_read2_b64 v[156:159], v254 offset0:129 offset1:128
    v_cvt_pk_bf16_f32 v202, v92, v93
    v_cvt_pk_bf16_f32 v203, v94, v95
    ds_read_b128 v[160:163], v8
    v_cvt_pk_bf16_f32 v204, v96, v97
    v_cvt_pk_bf16_f32 v205, v98, v99
    ds_read2_b64 v[164:167], v8 offset0:129 offset1:128
    v_cvt_pk_bf16_f32 v206, v100, v101
    v_cvt_pk_bf16_f32 v207, v102, v103
    ds_write_b64 v136, v[200:201]
    v_pk_mul_f32 v[104:105], v[104:105], v[144:145] op_sel_hi:[1,0]
    v_pk_mul_f32 v[106:107], v[106:107], v[144:145] op_sel_hi:[1,0]
    v_pk_mul_f32 v[108:109], v[108:109], v[144:145] op_sel_hi:[1,0]
    ds_write_b64 v137, v[202:203]
    v_pk_mul_f32 v[110:111], v[110:111], v[144:145] op_sel_hi:[1,0]
    v_pk_mul_f32 v[112:113], v[112:113], v[144:145] op_sel_hi:[1,0]
    ds_write_b64 v138, v[204:205]
    v_pk_mul_f32 v[114:115], v[114:115], v[144:145] op_sel_hi:[1,0]
    v_pk_mul_f32 v[116:117], v[116:117], v[144:145] op_sel_hi:[1,0]
    ds_write_b64 v139, v[206:207]
    v_pk_mul_f32 v[118:119], v[118:119], v[144:145] op_sel_hi:[1,0]
    v_cvt_pk_bf16_f32 v208, v104, v105
    v_cvt_pk_bf16_f32 v209, v106, v107
    s_waitcnt lgkmcnt(4)
    v_cvt_pk_bf16_f32 v210, v108, v109
    v_cvt_pk_bf16_f32 v211, v110, v111
    buffer_store_dwordx4 v[152:155], v6, s[52:55], s85 offen offset:0 sc1
    v_cvt_pk_bf16_f32 v212, v112, v113
    v_cvt_pk_bf16_f32 v213, v114, v115
    buffer_store_dwordx4 v[156:159], v6, s[52:55], s86 offen offset:0 sc1
    v_cvt_pk_bf16_f32 v214, v116, v117
    v_cvt_pk_bf16_f32 v215, v118, v119
    ds_write_b64 v140, v[208:209]
    ds_write_b64 v141, v[210:211]
    ds_write_b64 v142, v[212:213]
    ds_write_b64 v143, v[214:215]
    ds_read_b128 v[168:171], v254
    ds_read2_b64 v[172:175], v254 offset0:129 offset1:128
    ds_read_b128 v[176:179], v8
    ds_read2_b64 v[180:183], v8 offset0:129 offset1:128
    buffer_store_dwordx4 v[160:163], v6, s[52:55], s87 offen offset:0 sc1
    buffer_store_dwordx4 v[164:167], v6, s[52:55], s69 offen offset:0 sc1
    s_waitcnt lgkmcnt(3)
    buffer_store_dwordx4 v[168:171], v6, s[52:55], s85 offen offset:128 sc1
    s_waitcnt lgkmcnt(2)
    buffer_store_dwordx4 v[172:175], v6, s[52:55], s86 offen offset:128 sc1
    s_waitcnt lgkmcnt(1)
    buffer_store_dwordx4 v[176:179], v6, s[52:55], s87 offen offset:128 sc1
    s_waitcnt lgkmcnt(0)
    buffer_store_dwordx4 v[180:183], v6, s[52:55], s69 offen offset:128 sc1
L_fin:
    s_waitcnt vmcnt(0)
L_end:
    s_endpgm
L_pa1:
    s_sleep 1
    s_sub_u32 s90, s90, 1
    s_cbranch_scc1 L_end
    ds_read_b32 v10, v9
    s_waitcnt lgkmcnt(0)
    s_branch L_pb1
L_pa2:
    s_sleep 1
    s_sub_u32 s90, s90, 1
    s_cbranch_scc1 L_end
    ds_read_b32 v10, v9
    s_waitcnt lgkmcnt(0)
    s_branch L_pb2
L_pa3:
    s_sleep 1
    s_sub_u32 s90, s90, 1
    s_cbranch_scc1 L_end
    ds_read_b32 v10, v9
    s_waitcnt lgkmcnt(0)
    s_branch L_pb3
L_pa4:
    s_sleep 1
    s_sub_u32 s90, s90, 1
    s_cbranch_scc1 L_end
    ds_read_b32 v10, v9
    s_waitcnt lgkmcnt(0)
    s_branch L_pb4
L_pa5:
    s_sleep 1
    s_sub_u32 s90, s90, 1
    s_cbranch_scc1 L_end
    ds_read_b32 v10, v9
    s_waitcnt lgkmcnt(0)
    s_branch L_pb5
L_pa6:
    s_sleep 1
    s_sub_u32 s90, s90, 1
    s_cbranch_scc1 L_end
    ds_read_b32 v10, v9
    s_waitcnt lgkmcnt(0)
    s_branch L_pb6
L_lasts:
    ds_read_b64_tr_b16 v[152:153], v253 offset:0
    ds_read_b64_tr_b16 v[154:155], v253 offset:8192
    ds_read_b64_tr_b16 v[156:157], v253 offset:256
    v_fmamk_f32 v216, v120, 0x3e0293ee, v12
    v_fmamk_f32 v217, v121, 0x3e0293ee, v12
    v_fmamk_f32 v218, v122, 0x3e0293ee, v12
    v_fmamk_f32 v219, v123, 0x3e0293ee, v12
    v_mfma_f32_32x32x16_bf16 v[72:87], v[188:191], v[240:243], v[72:87]
    s_mov_b32 s69, 0x18000
    ds_read_b64_tr_b16 v[158:159], v253 offset:8448
    ds_read_b64_tr_b16 v[160:161], v253 offset:512
    v_exp_f32 v232, v216
    v_fmamk_f32 v220, v124, 0x3e0293ee, v12
    v_fmamk_f32 v221, v125, 0x3e0293ee, v12
    v_fmamk_f32 v222, v126, 0x3e0293ee, v12
    v_fmamk_f32 v223, v127, 0x3e0293ee, v12
    v_mfma_f32_32x32x16_bf16 v[88:103], v[192:195], v[240:243], v[88:103]
    s_mov_b32 s79, 6
    ds_read_b64_tr_b16 v[162:163], v253 offset:8704
    ds_read_b64_tr_b16 v[164:165], v253 offset:768
    v_exp_f32 v233, v217
    v_exp_f32 v234, v218
    v_mov_b32 v23, L_cnt-L_pc+124
    v_mfma_f32_32x32x16_bf16 v[104:119], v[196:199], v[240:243], v[104:119]
    s_waitcnt lgkmcnt(7)
    ds_read_b64_tr_b16 v[166:167], v253 offset:8960
    v_exp_f32 v235, v219
    v_exp_f32 v236, v220
    v_add_f32 v14, v232, v233
    v_add_f32 v14, v14, v234
    v_mfma_f32_32x32x16_bf16 v[56:71], v[200:203], v[244:247], v[56:71]
    v_exp_f32 v237, v221
    v_exp_f32 v238, v222
    v_cvt_pk_bf16_f32 v240, v232, v233
    v_add_f32 v14, v14, v235
    v_cvt_pk_bf16_f32 v241, v234, v235
    v_mfma_f32_32x32x16_bf16 v[72:87], v[204:207], v[244:247], v[72:87]
    v_exp_f32 v239, v223
    v_add_f32 v14, v14, v236
    v_add_f32 v14, v14, v237
    v_cvt_pk_bf16_f32 v242, v236, v237
    v_add_f32 v14, v14, v238
    v_mfma_f32_32x32x16_bf16 v[88:103], v[208:211], v[244:247], v[88:103]
    v_add_f32 v14, v14, v239
    v_cvt_pk_bf16_f32 v243, v238, v239
    v_cmp_lt_f32 vcc, s59, v14
    v_and_b32 v15, 31, v11
    v_lshrrev_b32 v16, 2, v11
    v_and_b32 v17, 7, v11
    v_lshrrev_b32 v18, 3, v11
    v_mfma_f32_32x32x16_bf16 v[104:119], v[212:215], v[244:247], v[104:119]
    s_waitcnt lgkmcnt(0)
    global_load_lds_dword v23, s[72:73]
    v_lshlrev_b32 v15, 7, v15
    v_xor_b32 v16, v16, v11
    v_xor_b32 v254, v17, v18
    v_and_b32 v16, 8, v16
    v_lshlrev_b32 v17, 4, v17
    v_add3_u32 v15, v15, v16, s81
    s_cbranch_vccnz L_resc8
L_ret6:
    v_add_f32 v13, v13, v14
    v_mfma_f32_32x32x16_bf16 v[56:71], v[152:155], v[240:243], v[56:71]
    v_mov_b32 v14, v13
    s_nop 1
    v_permlane32_swap_b32 v13, v14
    s_nop 1
    v_add_f32 v13, v13, v14
    v_rcp_f32 v144, v13
    v_mfma_f32_32x32x16_bf16 v[72:87], v[156:159], v[240:243], v[72:87]
    v_lshlrev_b32 v254, 4, v254
    v_lshlrev_b32 v16, 7, v18
    v_add_u32 v136, v15, v17
    v_lshl_add_u32 v6, v18, 12, v17
    v_add3_u32 v254, v254, v16, s81
    v_xor_b32 v137, 16, v136
    v_xor_b32 v138, 32, v136
    v_mfma_f32_32x32x16_bf16 v[88:103], v[160:163], v[240:243], v[88:103]
    v_xor_b32 v139, 48, v136
    v_xor_b32 v140, 64, v136
    v_xor_b32 v141, 80, v136
    v_xor_b32 v142, 96, v136
    v_xor_b32 v143, 112, v136
    v_add_u32 v8, 0x800, v254
    v_mfma_f32_32x32x16_bf16 v[104:119], v[164:167], v[240:243], v[104:119]
    v_mul_f32 v56, v56, v144
    v_mul_f32 v57, v57, v144
    v_mul_f32 v58, v58, v144
    v_mul_f32 v59, v59, v144
    v_mul_f32 v60, v60, v144
    v_mul_f32 v61, v61, v144
    v_mul_f32 v62, v62, v144
    v_mul_f32 v63, v63, v144
    v_mul_f32 v64, v64, v144
    v_mul_f32 v65, v65, v144
    v_mul_f32 v66, v66, v144
    v_mul_f32 v67, v67, v144
    v_mul_f32 v68, v68, v144
    v_mul_f32 v69, v69, v144
    v_mul_f32 v70, v70, v144
    v_mul_f32 v71, v71, v144
    v_cvt_pk_bf16_f32 v184, v56, v57
    v_cvt_pk_bf16_f32 v185, v58, v59
    v_cvt_pk_bf16_f32 v186, v60, v61
    v_cvt_pk_bf16_f32 v187, v62, v63
    v_cvt_pk_bf16_f32 v188, v64, v65
    v_cvt_pk_bf16_f32 v189, v66, v67
    v_cvt_pk_bf16_f32 v190, v68, v69
    v_cvt_pk_bf16_f32 v191, v70, v71
    s_branch L_tail3
L_resc8:
    v_fmamk_f32 v224, v128, 0x3e0293ee, v12
    v_fmamk_f32 v225, v129, 0x3e0293ee, v12
    v_fmamk_f32 v226, v130, 0x3e0293ee, v12
    v_fmamk_f32 v227, v131, 0x3e0293ee, v12
    v_fmamk_f32 v228, v132, 0x3e0293ee, v12
    v_fmamk_f32 v229, v133, 0x3e0293ee, v12
    v_fmamk_f32 v230, v134, 0x3e0293ee, v12
    v_fmamk_f32 v231, v135, 0x3e0293ee, v12
    s_branch L_resc
L_sync:
    s_setprio 0
    s_min_u32 s70, s66, s63
    s_cmp_eq_u32 s97, 0x20000
    s_cselect_b32 s71, 6, 2
    s_add_u32 s71, s66, s71
    s_min_u32 s71, s71, s58
    s_bfe_u32 s67, s20, 0x40008
    s_bfe_u32 s83, s21, 0x3000d
    s_bfe_u32 s96, s22, 0x3000d
    s_add_u32 s96, s96, 5
L_svc:
    ds_read_b32 v16, v0
    ds_read_b32 v10, v9
    s_cmp_lt_u32 s91, 8
    s_cselect_b32 s69, s67, 5
    s_cmp_eq_u32 s91, s96
    s_cselect_b32 s69, s83, s69
    s_sub_i32 s69, s91, s69
    s_cmp_gt_u32 s91, s71
    s_waitcnt lgkmcnt(0)
    s_cbranch_scc0 L_svc1
    v_cmp_ge_u32 vcc, s70, v10
    s_cbranch_vccz L_svcx
    s_cmp_gt_u32 s91, s58
    s_cbranch_scc1 L_svcs
L_svc1:
    v_cmp_gt_i32 vcc, s69, v16
    s_bitcmp1_b32 s91, 0
    s_cbranch_scc1 L_svcB
    s_cmp_lt_u32 s91, 8
    s_cselect_b32 s69, -1, s17
    s_and_b32 s69, s69, vcc_lo
    s_and_b32 s69, s69, 0xff
    s_cbranch_scc1 L_svc2
    s_add_u32 s91, s91, 1
    s_waitcnt vmcnt(20)
    s_mov_b32 m0, s61
    s_nop 0
    buffer_load_dwordx4 v3, s[40:43], s60 offen offset:3072  lds
    buffer_load_dwordx4 v1, s[32:35], s60 offen offset:1024  lds
    s_add_u32 m0, s61, 0x4000
    s_nop 0
    buffer_load_dwordx4 v4, s[40:43], s60 offen offset:3072  lds
    buffer_load_dwordx4 v2, s[32:35], s60 offen offset:1024  lds
    s_mov_b32 m0, s93
    v_add_u32 v23, 4, v23
    global_load_lds_dword v23, s[72:73]
    s_branch L_svc
L_svcB:
    s_and_b32 s69, s19, 0xff
    s_cmp_gt_u32 s91, s69
    s_cbranch_scc1 L_svcF
    s_cbranch_vccnz L_svc2
    s_waitcnt vmcnt(20)
    s_mov_b32 m0, s61
    s_nop 0
    buffer_load_dwordx4 v3, s[44:47], s60 offen offset:2048  lds
    buffer_load_dwordx4 v1, s[36:39], s60 offen  lds
    s_add_u32 m0, s61, 0x4000
    s_nop 0
    buffer_load_dwordx4 v4, s[44:47], s60 offen offset:2048  lds
    buffer_load_dwordx4 v2, s[36:39], s60 offen  lds
L_svcF:
    s_add_u32 s91, s91, 1
    s_mov_b32 m0, s93
    v_add_u32 v23, 4, v23
    global_load_lds_dword v23, s[72:73]
    s_add_u32 s60, s60, s97
    s_add_u32 s61, s61, 0x8000
    s_and_b32 s61, s61, 0x1ffff
    s_branch L_svc
L_svc2:
    v_cmp_ge_u32 vcc, s70, v10
    s_cbranch_vccz L_svcx
L_svcs:
    s_sleep 2
    s_sub_u32 s90, s90, 1
    s_cbranch_scc1 L_end
    s_branch L_svc
L_svcx:
    s_setprio 3
    s_cmp_eq_u32 s89, 2
    s_cbranch_scc1 L_sr2
    s_cmp_eq_u32 s89, 1
    s_cbranch_scc1 L_sr1
    s_cmp_eq_u32 s89, 0
    s_cbranch_scc1 L_head
    s_branch L_sr3
L_hdone:
    s_mov_b32 s66, s58
    s_mov_b32 s63, s58
    s_mov_b32 s89, 3
    s_branch L_sync
L_sr3:
    s_setprio 0
L_hfree:
    s_sub_u32 s70, s58, 1
    s_bfe_u32 s58, s26, 0x40018
    s_cbranch_scc0 L_fin
    s_cmp_eq_u32 s58, 1
    s_cbranch_scc1 L_solo
L_pe1:
    s_waitcnt lgkmcnt(0)
    v_cmp_gt_u32 vcc, s70, v14
    s_cbranch_vccnz L_pe0
    s_cmp_eq_u32 s58, 2
    ds_write_b128 v238, v[104:107] offset:0
    ds_write_b128 v238, v[108:111] offset:1024
    ds_write_b128 v238, v[112:115] offset:2048
    ds_write_b128 v238, v[116:119] offset:3072
    ds_write_b128 v237, v[88:91] offset:0
    ds_write_b128 v237, v[92:95] offset:1024
    ds_write_b128 v237, v[96:99] offset:2048
    ds_write_b128 v237, v[100:103] offset:3072
    s_cbranch_scc1 L_sd2
    ds_write_b128 v236, v[72:75] offset:0
    ds_write_b128 v236, v[76:79] offset:1024
    ds_write_b128 v236, v[80:83] offset:2048
    ds_write_b128 v236, v[84:87] offset:3072
L_sd2:
    s_mov_b64 exec, 1
    ds_add_u32 v249, v251
    s_mov_b64 exec, -1
    s_waitcnt lgkmcnt(0)
L_rx:
    ds_read_b32 v18, v249
    ds_read_b64 v[216:217], v232
    ds_read_b64 v[218:219], v233
    ds_read_b64 v[220:221], v234
    ds_read_b128 v[168:171], v250 offset:0
    ds_read_b128 v[172:175], v250 offset:1024
    ds_read_b128 v[176:179], v250 offset:2048
    ds_read_b128 v[180:183], v250 offset:3072
    ds_read_b128 v[184:187], v250 offset:4096
    ds_read_b128 v[188:191], v250 offset:5120
    ds_read_b128 v[192:195], v250 offset:6144
    ds_read_b128 v[196:199], v250 offset:7168
    ds_read_b128 v[200:203], v250 offset:8192
    ds_read_b128 v[204:207], v250 offset:9216
    ds_read_b128 v[208:211], v250 offset:10240
    s_waitcnt lgkmcnt(14)
    v_cmp_ne_u32 vcc, s58, v18
    ds_read_b128 v[212:215], v250 offset:11264
    s_cbranch_vccnz L_poll
    s_bfe_u32 s85, s26, 0x2001c
    s_lshl_b32 s85, s85, 6
    s_add_u32 s86, s85, 0x8000
    s_add_u32 s87, s85, 0x10000
    s_add_u32 s69, s85, 0x18000
    s_waitcnt lgkmcnt(12)
    v_min3_f32 v18, v12, v216, v218
    v_min_f32 v18, v18, v220
    v_sub_f32 v224, v18, v12
    v_sub_f32 v226, v18, v216
    v_sub_f32 v228, v18, v218
    v_sub_f32 v230, v18, v220
    v_exp_f32 v224, v224
    v_exp_f32 v226, v226
    v_exp_f32 v228, v228
    v_exp_f32 v230, v230
    v_mul_f32 v13, v13, v224
    v_fmac_f32 v13, v217, v226
    s_cmp_eq_u32 s58, 2
    s_cbranch_scc1 L_mg2
    v_fmac_f32 v13, v219, v228
    v_fmac_f32 v13, v221, v230
    v_rcp_f32 v18, v13
    v_and_b32 v15, 4, v11
    v_lshl_add_u32 v6, v15, 28, v6
    v_mul_f32 v224, v224, v18
    v_mul_f32 v226, v226, v18
    v_mul_f32 v228, v228, v18
    v_mul_f32 v230, v230, v18
    v_pk_mul_f32 v[56:57], v[56:57], v[224:225] op_sel_hi:[1,0]
    v_pk_mul_f32 v[58:59], v[58:59], v[224:225] op_sel_hi:[1,0]
    v_pk_mul_f32 v[60:61], v[60:61], v[224:225] op_sel_hi:[1,0]
    v_pk_mul_f32 v[62:63], v[62:63], v[224:225] op_sel_hi:[1,0]
    v_pk_mul_f32 v[64:65], v[64:65], v[224:225] op_sel_hi:[1,0]
    v_pk_mul_f32 v[66:67], v[66:67], v[224:225] op_sel_hi:[1,0]
    v_pk_mul_f32 v[68:69], v[68:69], v[224:225] op_sel_hi:[1,0]
    v_pk_mul_f32 v[70:71], v[70:71], v[224:225] op_sel_hi:[1,0]
    s_waitcnt lgkmcnt(8)
    v_pk_fma_f32 v[56:57], v[168:169], v[226:227], v[56:57] op_sel_hi:[1,0,1]
    v_pk_fma_f32 v[58:59], v[170:171], v[226:227], v[58:59] op_sel_hi:[1,0,1]
    v_pk_fma_f32 v[60:61], v[172:173], v[226:227], v[60:61] op_sel_hi:[1,0,1]
    v_pk_fma_f32 v[62:63], v[174:175], v[226:227], v[62:63] op_sel_hi:[1,0,1]
    v_pk_fma_f32 v[64:65], v[176:177], v[226:227], v[64:65] op_sel_hi:[1,0,1]
    v_pk_fma_f32 v[66:67], v[178:179], v[226:227], v[66:67] op_sel_hi:[1,0,1]
    v_pk_fma_f32 v[68:69], v[180:181], v[226:227], v[68:69] op_sel_hi:[1,0,1]
    v_pk_fma_f32 v[70:71], v[182:183], v[226:227], v[70:71] op_sel_hi:[1,0,1]
    s_waitcnt lgkmcnt(4)
    v_pk_fma_f32 v[56:57], v[184:185], v[228:229], v[56:57] op_sel_hi:[1,0,1]
    v_pk_fma_f32 v[58:59], v[186:187], v[228:229], v[58:59] op_sel_hi:[1,0,1]
    v_pk_fma_f32 v[60:61], v[188:189], v[228:229], v[60:61] op_sel_hi:[1,0,1]
    v_pk_fma_f32 v[62:63], v[190:191], v[228:229], v[62:63] op_sel_hi:[1,0,1]
    v_pk_fma_f32 v[64:65], v[192:193], v[228:229], v[64:65] op_sel_hi:[1,0,1]
    v_pk_fma_f32 v[66:67], v[194:195], v[228:229], v[66:67] op_sel_hi:[1,0,1]
    v_pk_fma_f32 v[68:69], v[196:197], v[228:229], v[68:69] op_sel_hi:[1,0,1]
    v_pk_fma_f32 v[70:71], v[198:199], v[228:229], v[70:71] op_sel_hi:[1,0,1]
    s_waitcnt lgkmcnt(0)
    v_pk_fma_f32 v[56:57], v[200:201], v[230:231], v[56:57] op_sel_hi:[1,0,1]
    v_pk_fma_f32 v[58:59], v[202:203], v[230:231], v[58:59] op_sel_hi:[1,0,1]
    v_pk_fma_f32 v[60:61], v[204:205], v[230:231], v[60:61] op_sel_hi:[1,0,1]
    v_pk_fma_f32 v[62:63], v[206:207], v[230:231], v[62:63] op_sel_hi:[1,0,1]
    v_pk_fma_f32 v[64:65], v[208:209], v[230:231], v[64:65] op_sel_hi:[1,0,1]
    v_pk_fma_f32 v[66:67], v[210:211], v[230:231], v[66:67] op_sel_hi:[1,0,1]
    v_pk_fma_f32 v[68:69], v[212:213], v[230:231], v[68:69] op_sel_hi:[1,0,1]
    v_pk_fma_f32 v[70:71], v[214:215], v[230:231], v[70:71] op_sel_hi:[1,0,1]
    s_branch L_mg3
L_mg2:
    v_rcp_f32 v18, v13
    s_nop 0
    v_mul_f32 v224, v224, v18
    v_mul_f32 v226, v226, v18
    v_pk_mul_f32 v[56:57], v[56:57], v[224:225] op_sel_hi:[1,0]
    v_pk_mul_f32 v[58:59], v[58:59], v[224:225] op_sel_hi:[1,0]
    v_pk_mul_f32 v[60:61], v[60:61], v[224:225] op_sel_hi:[1,0]
    v_pk_mul_f32 v[62:63], v[62:63], v[224:225] op_sel_hi:[1,0]
    v_pk_mul_f32 v[64:65], v[64:65], v[224:225] op_sel_hi:[1,0]
    v_pk_mul_f32 v[66:67], v[66:67], v[224:225] op_sel_hi:[1,0]
    v_pk_mul_f32 v[68:69], v[68:69], v[224:225] op_sel_hi:[1,0]
    v_pk_mul_f32 v[70:71], v[70:71], v[224:225] op_sel_hi:[1,0]
    v_pk_mul_f32 v[72:73], v[72:73], v[224:225] op_sel_hi:[1,0]
    v_pk_mul_f32 v[74:75], v[74:75], v[224:225] op_sel_hi:[1,0]
    v_pk_mul_f32 v[76:77], v[76:77], v[224:225] op_sel_hi:[1,0]
    v_pk_mul_f32 v[78:79], v[78:79], v[224:225] op_sel_hi:[1,0]
    v_pk_mul_f32 v[80:81], v[80:81], v[224:225] op_sel_hi:[1,0]
    v_pk_mul_f32 v[82:83], v[82:83], v[224:225] op_sel_hi:[1,0]
    v_pk_mul_f32 v[84:85], v[84:85], v[224:225] op_sel_hi:[1,0]
    v_pk_mul_f32 v[86:87], v[86:87], v[224:225] op_sel_hi:[1,0]
    s_waitcnt lgkmcnt(4)
    v_pk_fma_f32 v[56:57], v[168:169], v[226:227], v[56:57] op_sel_hi:[1,0,1]
    v_pk_fma_f32 v[58:59], v[170:171], v[226:227], v[58:59] op_sel_hi:[1,0,1]
    v_pk_fma_f32 v[60:61], v[172:173], v[226:227], v[60:61] op_sel_hi:[1,0,1]
    v_pk_fma_f32 v[62:63], v[174:175], v[226:227], v[62:63] op_sel_hi:[1,0,1]
    v_pk_fma_f32 v[64:65], v[176:177], v[226:227], v[64:65] op_sel_hi:[1,0,1]
    v_pk_fma_f32 v[66:67], v[178:179], v[226:227], v[66:67] op_sel_hi:[1,0,1]
    v_pk_fma_f32 v[68:69], v[180:181], v[226:227], v[68:69] op_sel_hi:[1,0,1]
    v_pk_fma_f32 v[70:71], v[182:183], v[226:227], v[70:71] op_sel_hi:[1,0,1]
    v_pk_fma_f32 v[72:73], v[184:185], v[226:227], v[72:73] op_sel_hi:[1,0,1]
    v_pk_fma_f32 v[74:75], v[186:187], v[226:227], v[74:75] op_sel_hi:[1,0,1]
    v_pk_fma_f32 v[76:77], v[188:189], v[226:227], v[76:77] op_sel_hi:[1,0,1]
    v_pk_fma_f32 v[78:79], v[190:191], v[226:227], v[78:79] op_sel_hi:[1,0,1]
    v_pk_fma_f32 v[80:81], v[192:193], v[226:227], v[80:81] op_sel_hi:[1,0,1]
    v_pk_fma_f32 v[82:83], v[194:195], v[226:227], v[82:83] op_sel_hi:[1,0,1]
    v_pk_fma_f32 v[84:85], v[196:197], v[226:227], v[84:85] op_sel_hi:[1,0,1]
    v_pk_fma_f32 v[86:87], v[198:199], v[226:227], v[86:87] op_sel_hi:[1,0,1]
    v_cvt_pk_bf16_f32 v192, v72, v73
    v_cvt_pk_bf16_f32 v193, v74, v75
    v_cvt_pk_bf16_f32 v194, v76, v77
    v_cvt_pk_bf16_f32 v195, v78, v79
    v_cvt_pk_bf16_f32 v196, v80, v81
    v_cvt_pk_bf16_f32 v197, v82, v83
    v_cvt_pk_bf16_f32 v198, v84, v85
    v_cvt_pk_bf16_f32 v199, v86, v87
    ds_write_b64 v140, v[192:193]
    ds_write_b64 v141, v[194:195]
    ds_write_b64 v142, v[196:197]
    ds_write_b64 v143, v[198:199]
L_mg3:
    v_cvt_pk_bf16_f32 v184, v56, v57
    v_cvt_pk_bf16_f32 v185, v58, v59
    v_cvt_pk_bf16_f32 v186, v60, v61
    v_cvt_pk_bf16_f32 v187, v62, v63
    v_cvt_pk_bf16_f32 v188, v64, v65
    v_cvt_pk_bf16_f32 v189, v66, v67
    v_cvt_pk_bf16_f32 v190, v68, v69
    v_cvt_pk_bf16_f32 v191, v70, v71
    ds_write_b64 v136, v[184:185]
    ds_write_b64 v137, v[186:187]
    ds_write_b64 v138, v[188:189]
    ds_write_b64 v139, v[190:191]
    ds_read_b128 v[152:155], v254
    ds_read2_b64 v[156:159], v254 offset0:129 offset1:128
    ds_read_b128 v[160:163], v8
    ds_read2_b64 v[164:167], v8 offset0:129 offset1:128
    s_waitcnt lgkmcnt(3)
    buffer_store_dwordx4 v[152:155], v6, s[52:55], s85 offen offset:0 sc1
    s_waitcnt lgkmcnt(2)
    buffer_store_dwordx4 v[156:159], v6, s[52:55], s86 offen offset:0 sc1
    s_waitcnt lgkmcnt(1)
    buffer_store_dwordx4 v[160:163], v6, s[52:55], s87 offen offset:0 sc1
    s_waitcnt lgkmcnt(0)
    buffer_store_dwordx4 v[164:167], v6, s[52:55], s69 offen offset:0 sc1
    s_branch L_fin
L_pe0:
    s_sleep 2
    s_sub_u32 s90, s90, 1
    s_cbranch_scc1 L_end
    ds_read_b32 v14, v0
    s_branch L_pe1
L_poll:
    s_sleep 1
    s_sub_u32 s90, s90, 1
    s_cbranch_scc1 L_end
    ds_read_b32 v18, v249
    s_waitcnt lgkmcnt(0)
    v_cmp_ne_u32 vcc, s58, v18
    s_cbranch_vccnz L_poll
    s_branch L_rx
L_resc:
    v_max3_f32 v232, v216, v217, v218
    v_max3_f32 v232, v232, v219, v220
    v_max3_f32 v232, v232, v221, v222
    v_max3_f32 v232, v232, v223, v224
    v_max3_f32 v232, v232, v225, v226
    v_max3_f32 v232, v232, v227, v228
    v_max3_f32 v232, v232, v229, v230
    v_max3_f32 v232, v232, v231, 0
    v_mov_b32 v233, v232
    s_nop 1
    v_permlane32_swap_b32 v232, v233
    s_nop 1
    v_max_f32 v232, v232, v233
    v_exp_f32 v233, -v232
    v_sub_f32 v12, v12, v232
    v_sub_f32 v216, v216, v232
    v_sub_f32 v217, v217, v232
    v_sub_f32 v218, v218, v232
    v_sub_f32 v219, v219, v232
    v_sub_f32 v220, v220, v232
    v_sub_f32 v221, v221, v232
    v_sub_f32 v222, v222, v232
    v_sub_f32 v223, v223, v232
    v_sub_f32 v224, v224, v232
    v_sub_f32 v225, v225, v232
    v_sub_f32 v226, v226, v232
    v_sub_f32 v227, v227, v232
    v_sub_f32 v228, v228, v232
    v_sub_f32 v229, v229, v232
    v_sub_f32 v230, v230, v232
    v_sub_f32 v231, v231, v232
    v_mul_f32 v13, v13, v233
    v_mul_f32 v56, v56, v233
    v_mul_f32 v57, v57, v233
    v_mul_f32 v58, v58, v233
    v_mul_f32 v59, v59, v233
    v_mul_f32 v60, v60, v233
    v_mul_f32 v61, v61, v233
    v_mul_f32 v62, v62, v233
    v_mul_f32 v63, v63, v233
    v_mul_f32 v64, v64, v233
    v_mul_f32 v65, v65, v233
    v_mul_f32 v66, v66, v233
    v_mul_f32 v67, v67, v233
    v_mul_f32 v68, v68, v233
    v_mul_f32 v69, v69, v233
    v_mul_f32 v70, v70, v233
    v_mul_f32 v71, v71, v233
    v_mul_f32 v72, v72, v233
    v_mul_f32 v73, v73, v233
    v_mul_f32 v74, v74, v233
    v_mul_f32 v75, v75, v233
    v_mul_f32 v76, v76, v233
    v_mul_f32 v77, v77, v233
    v_mul_f32 v78, v78, v233
    v_mul_f32 v79, v79, v233
    v_mul_f32 v80, v80, v233
    v_mul_f32 v81, v81, v233
    v_mul_f32 v82, v82, v233
    v_mul_f32 v83, v83, v233
    v_mul_f32 v84, v84, v233
    v_mul_f32 v85, v85, v233
    v_mul_f32 v86, v86, v233
    v_mul_f32 v87, v87, v233
    v_mul_f32 v88, v88, v233
    v_mul_f32 v89, v89, v233
    v_mul_f32 v90, v90, v233
    v_mul_f32 v91, v91, v233
    v_mul_f32 v92, v92, v233
    v_mul_f32 v93, v93, v233
    v_mul_f32 v94, v94, v233
    v_mul_f32 v95, v95, v233
    v_mul_f32 v96, v96, v233
    v_mul_f32 v97, v97, v233
    v_mul_f32 v98, v98, v233
    v_mul_f32 v99, v99, v233
    v_mul_f32 v100, v100, v233
    v_mul_f32 v101, v101, v233
    v_mul_f32 v102, v102, v233
    v_mul_f32 v103, v103, v233
    v_mul_f32 v104, v104, v233
    v_mul_f32 v105, v105, v233
    v_mul_f32 v106, v106, v233
    v_mul_f32 v107, v107, v233
    v_mul_f32 v108, v108, v233
    v_mul_f32 v109, v109, v233
    v_mul_f32 v110, v110, v233
    v_mul_f32 v111, v111, v233
    v_mul_f32 v112, v112, v233
    v_mul_f32 v113, v113, v233
    v_mul_f32 v114, v114, v233
    v_mul_f32 v115, v115, v233
    v_mul_f32 v116, v116, v233
    v_mul_f32 v117, v117, v233
    v_mul_f32 v118, v118, v233
    v_mul_f32 v119, v119, v233
    v_exp_f32 v232, v216
    v_exp_f32 v233, v217
    v_exp_f32 v234, v218
    v_exp_f32 v235, v219
    v_exp_f32 v236, v220
    v_exp_f32 v237, v221
    v_exp_f32 v238, v222
    v_exp_f32 v239, v223
    v_add_f32 v14, v232, v233
    v_add_f32 v14, v14, v234
    v_add_f32 v14, v14, v235
    v_add_f32 v14, v14, v236
    v_add_f32 v14, v14, v237
    v_add_f32 v14, v14, v238
    v_add_f32 v14, v14, v239
    v_cvt_pk_bf16_f32 v240, v232, v233
    v_cvt_pk_bf16_f32 v241, v234, v235
    v_cvt_pk_bf16_f32 v242, v236, v237
    v_cvt_pk_bf16_f32 v243, v238, v239
    v_exp_f32 v232, v224
    v_exp_f32 v233, v225
    v_exp_f32 v234, v226
    v_exp_f32 v235, v227
    v_exp_f32 v236, v228
    v_exp_f32 v237, v229
    v_exp_f32 v238, v230
    v_exp_f32 v239, v231
    v_add_f32 v14, v14, v232
    v_add_f32 v14, v14, v233
    v_add_f32 v14, v14, v234
    v_add_f32 v14, v14, v235
    v_add_f32 v14, v14, v236
    v_add_f32 v14, v14, v237
    v_add_f32 v14, v14, v238
    v_add_f32 v14, v14, v239
    v_cvt_pk_bf16_f32 v244, v232, v233
    v_cvt_pk_bf16_f32 v245, v234, v235
    v_cvt_pk_bf16_f32 v246, v236, v237
    v_cvt_pk_bf16_f32 v247, v238, v239
    s_cmp_eq_u32 s79, 0
    s_cbranch_scc1 L_ret0
    s_cmp_eq_u32 s79, 1
    s_cbranch_scc1 L_ret1
    s_cmp_eq_u32 s79, 2
    s_cbranch_scc1 L_ret2
    s_cmp_eq_u32 s79, 3
    s_cbranch_scc1 L_ret3
    s_cmp_eq_u32 s79, 4
    s_cbranch_scc1 L_ret4
    s_cmp_eq_u32 s79, 5
    s_cbranch_scc1 L_ret5
    s_branch L_ret6
.p2align 6
.type L_near,@object
L_near:
    .long 0x121000, 0xe6103, 0x509000, 0x70109, 0x20511, 0x201a1e1, 0x1529f509, 0x15691549
    .long 0x57a000, 0x10713f, 0x59a000, 0xe7109, 0x4040b, 0x59aa57a, 0x5dae5ba, 0x61a05fa
    .long 0x3ab000, 0x15d15f, 0x3cb000, 0x13d10b, 0x4040d, 0x3cba3ab, 0x40be3eb, 0xfff042b
    .long 0x3ab000, 0x15d15f, 0x3cb000, 0x13d10b, 0x4040d, 0x46ba44b, 0x4abe48b, 0xfff04cb
    .long 0x3ab000, 0x15d101, 0x57a000, 0x107113, 0x20517, 0x163aa4eb, 0x167af65a, 0xfff0fff
    .long 0x121000, 0xe613f, 0x141000, 0xc6109, 0x40309, 0x141a121, 0x181e161, 0x1c101a1
    .long 0x682000, 0x13215f, 0x6a2000, 0x11210b, 0x4030b, 0x6a2a682, 0x6e2e6c2, 0xfff0702
    .long 0x682000, 0x13215f, 0x6a2000, 0x11210b, 0x4030b, 0x742a722, 0x782e762, 0xfff07a2
    .long 0x7b5000, 0x12d15f, 0x7d5000, 0x10d10b, 0x4030b, 0x7d5a7b5, 0x815e7f5, 0xfff0835
    .long 0x7b5000, 0x12d15f, 0x7d5000, 0x10d10b, 0x4020b, 0x875a855, 0x8b5e895, 0xfff08d5
    .long 0x0, 0x12015f, 0x20000, 0x10010b, 0x4020b, 0x20a000, 0x60e040, 0xfff0080
    .long 0x0, 0x12015f, 0x20000, 0x10010b, 0x4020b, 0xc0a0a0, 0x100e0e0, 0xfff0120
    .long 0x208000, 0x1a210f, 0x228000, 0x18210f, 0x4020f, 0x2284208, 0x268c248, 0xfff0fff
    .long 0x208000, 0x1a210f, 0x228000, 0x18210f, 0x4020f, 0x2a84288, 0x2e8c2c8, 0xfff0fff
    .long 0x208000, 0x1a2107, 0x228000, 0x18210f, 0x4020f, 0x3284308, 0xfffc348, 0xfff0fff
    .long 0x208000, 0x1a2107, 0x228000, 0x18210f, 0x4020f, 0x3884368, 0xfffc3a8, 0xfff0fff
L_far:
    .long 0x1e1010, 0x1f100, 0x72207, 0x4000402, 0x85020000, 0x7f, 0x2, 0x0
    .long 0x201010, 0x6100, 0x72207, 0x4000402, 0x85121000, 0x7f, 0x2, 0x0
    .long 0x509009, 0x1f100, 0x112203, 0x5010502, 0x4222000, 0x7, 0x3, 0x0
    .long 0x529009, 0x1f100, 0x112203, 0x5010502, 0x4323000, 0x7, 0x3, 0x0
    .long 0x0, 0x0, 0x0, 0x0, 0x0, 0x0, 0x0, 0x0
    .long 0x0, 0x0, 0x0, 0x0, 0x0, 0x0, 0x0, 0x0
    .long 0x549009, 0x1f100, 0x1112303, 0x3030503, 0x4424000, 0x0, 0x0, 0x0
    .long 0x569009, 0x10100, 0x1112303, 0x3030503, 0x4525000, 0x0, 0x0, 0x0
    .long 0x57a00a, 0x1f100, 0x81108, 0x2000402, 0x85020000, 0x3, 0x1, 0x0
    .long 0x59a00a, 0x1f100, 0x81108, 0x2000402, 0x85121000, 0x3, 0x1, 0x0
    .long 0x5ba00a, 0x1f100, 0x81108, 0x2000402, 0x85222000, 0x3, 0x1, 0x0
    .long 0x5da00a, 0x1f100, 0x81108, 0x2000402, 0x85323000, 0x3, 0x1, 0x0
    .long 0x5fa00a, 0x1f100, 0x2082304, 0x2030402, 0x5410000, 0x2000000, 0x2018000, 0x2019000
    .long 0x61a00a, 0x1f100, 0x42082304, 0x2030402, 0x5513000, 0x3000000, 0x301b000, 0x301c000
    .long 0x5fa009, 0x1f100, 0x22202303, 0x3030503, 0x4418000, 0x0, 0x10000, 0x11000
    .long 0x61a009, 0x1f100, 0x62202303, 0x3030503, 0x451b000, 0x1000000, 0x1013000, 0x1014000
    .long 0x3ab00c, 0x1f100, 0x1e110a, 0x2000402, 0x5020000, 0x3, 0x1, 0x0
    .long 0x3cb00c, 0x1f100, 0x1e110a, 0x2000402, 0x5121000, 0x3, 0x1, 0x0
    .long 0x3eb00c, 0x1f100, 0x1e110a, 0x2000402, 0x5222000, 0x3, 0x1, 0x0
    .long 0x40b00c, 0x1f100, 0x1e110a, 0x2000402, 0x5323000, 0x3, 0x1, 0x0
    .long 0x42b00a, 0x1f100, 0x4204302, 0x4030402, 0x9418000, 0x301b000, 0x2001000, 0x1005000
    .long 0x42b00b, 0x1f100, 0x14204302, 0x5030503, 0x841b000, 0x0, 0x3004000, 0x201a000
    .long 0x42b00c, 0x1f100, 0x241e4302, 0x6030604, 0xb400000, 0x1003000, 0x19000, 0x301d000
    .long 0x42b009, 0x1f100, 0x34204301, 0x7030705, 0xa403000, 0x2018000, 0x101c000, 0x2000
    .long 0x44b00c, 0x1f100, 0x1e110a, 0x2000402, 0x5020000, 0x3, 0x1, 0x0
    .long 0x46b00c, 0x1f100, 0x1e110a, 0x2000402, 0x5121000, 0x3, 0x1, 0x0
    .long 0x48b00c, 0x1f100, 0x1e110a, 0x2000402, 0x5222000, 0x3, 0x1, 0x0
    .long 0x4ab00c, 0x1f100, 0x1e110a, 0x2000402, 0x5323000, 0x3, 0x1, 0x0
    .long 0x4cb00a, 0x1f100, 0x4204302, 0x4030402, 0x9418000, 0x301b000, 0x2001000, 0x1005000
    .long 0x4cb00b, 0x1f100, 0x14204302, 0x5030503, 0x841b000, 0x0, 0x3004000, 0x201a000
    .long 0x4cb00c, 0x1f100, 0x241e4302, 0x6030604, 0xb400000, 0x1003000, 0x19000, 0x301d000
    .long 0x4cb009, 0x1f100, 0x34204301, 0x7030705, 0xa403000, 0x2018000, 0x101c000, 0x2000
    .long 0x4eb016, 0x1d100, 0x1e220a, 0x4000402, 0x5020000, 0x3ff, 0x2, 0x0
    .long 0x63a013, 0x1f100, 0x82208, 0x5010502, 0x84121000, 0xff, 0x3, 0x0
    .long 0x65a013, 0x1f100, 0x82208, 0x5010502, 0x84222000, 0xff, 0x3, 0x0
    .long 0x67a013, 0x7100, 0x82208, 0x5010502, 0x84323000, 0xff, 0x3, 0x0
    .long 0x0, 0x0, 0x0, 0x0, 0x0, 0x0, 0x0, 0x0
    .long 0x0, 0x0, 0x0, 0x0, 0x0, 0x0, 0x0, 0x0
    .long 0x0, 0x0, 0x0, 0x0, 0x0, 0x0, 0x0, 0x0
    .long 0x0, 0x0, 0x0, 0x0, 0x0, 0x0, 0x0, 0x0
    .long 0x121009, 0x1f100, 0x71107, 0x2000402, 0x85020000, 0x3, 0x1, 0x0
    .long 0x141009, 0x1f100, 0x71107, 0x2000402, 0x85121000, 0x3, 0x1, 0x0
    .long 0x161009, 0x1f100, 0x71107, 0x2000402, 0x85222000, 0x3, 0x1, 0x0
    .long 0x181009, 0x1f100, 0x71107, 0x2000402, 0x85323000, 0x3, 0x1, 0x0
    .long 0x1a1008, 0x1f100, 0x2202303, 0x2030402, 0x5408000, 0x2000000, 0x2010000, 0x2011000
    .long 0x1c1008, 0x1f100, 0x42202303, 0x2030402, 0x550b000, 0x3000000, 0x3013000, 0x3014000
    .long 0x1a1009, 0x1f100, 0x22072303, 0x3030503, 0x4410000, 0x0, 0x8000, 0x9000
    .long 0x1c1009, 0x1f100, 0x62072303, 0x3030503, 0x4513000, 0x1000000, 0x100b000, 0x100c000
    .long 0x68200b, 0x1f100, 0x131109, 0x2000402, 0x5020000, 0x3, 0x1, 0x0
    .long 0x6a200b, 0x1f100, 0x131109, 0x2000402, 0x5121000, 0x3, 0x1, 0x0
    .long 0x6c200b, 0x1f100, 0x131109, 0x2000402, 0x5222000, 0x3, 0x1, 0x0
    .long 0x6e200b, 0x1f100, 0x131109, 0x2000402, 0x5323000, 0x3, 0x1, 0x0
    .long 0x70200a, 0x1f100, 0x4204302, 0x4030402, 0x9410000, 0x3013000, 0x2019000, 0x101d000
    .long 0x70200b, 0x1f100, 0x14134302, 0x5030503, 0x8413000, 0x18000, 0x301c000, 0x2012000
    .long 0x702008, 0x1f100, 0x24204301, 0x6030604, 0xb418000, 0x101b000, 0x11000, 0x3015000
    .long 0x702009, 0x1f100, 0x34204301, 0x7030705, 0xa41b000, 0x2010000, 0x1014000, 0x1a000
    .long 0x72200b, 0x1f100, 0x131109, 0x2000402, 0x5020000, 0x3, 0x1, 0x0
    .long 0x74200b, 0x1f100, 0x131109, 0x2000402, 0x5121000, 0x3, 0x1, 0x0
    .long 0x76200b, 0x1f100, 0x131109, 0x2000402, 0x5222000, 0x3, 0x1, 0x0
    .long 0x78200b, 0x1f100, 0x131109, 0x2000402, 0x5323000, 0x3, 0x1, 0x0
    .long 0x7a200a, 0x12100, 0x4204302, 0x4030402, 0x9410000, 0x3013000, 0x2019000, 0x101d000
    .long 0x7a200b, 0x12100, 0x14134302, 0x5030503, 0x8413000, 0x18000, 0x301c000, 0x2012000
    .long 0x7a2008, 0x12100, 0x24204301, 0x6030604, 0xb418000, 0x101b000, 0x11000, 0x3015000
    .long 0x7a2009, 0x12100, 0x34204301, 0x7030705, 0xa41b000, 0x2010000, 0x1014000, 0x1a000
    .long 0x7b500b, 0x1f100, 0xe1109, 0x2000402, 0x85020000, 0x3, 0x1, 0x0
    .long 0x7d500b, 0x1f100, 0xe1109, 0x2000402, 0x85121000, 0x3, 0x1, 0x0
    .long 0x7f500b, 0x1f100, 0xe1109, 0x2000402, 0x85222000, 0x3, 0x1, 0x0
    .long 0x81500b, 0x1f100, 0xe1109, 0x2000402, 0x85323000, 0x3, 0x1, 0x0
    .long 0x83500a, 0x1f100, 0x4204302, 0x4030402, 0x9410000, 0x3013000, 0x2019000, 0x101d000
    .long 0x83500b, 0x1f100, 0x140e4302, 0x5030503, 0x8413000, 0x18000, 0x301c000, 0x2012000
    .long 0x835008, 0x1f100, 0x24204301, 0x6030604, 0xb418000, 0x101b000, 0x11000, 0x3015000
    .long 0x835009, 0x1f100, 0x34204301, 0x7030705, 0xa41b000, 0x2010000, 0x1014000, 0x1a000
    .long 0x85500b, 0x1f100, 0xe1109, 0x2000402, 0x85020000, 0x3, 0x1, 0x0
    .long 0x87500b, 0x1f100, 0xe1109, 0x2000402, 0x85121000, 0x3, 0x1, 0x0
    .long 0x89500b, 0x1f100, 0xe1109, 0x2000402, 0x85222000, 0x3, 0x1, 0x0
    .long 0x8b500b, 0x1f100, 0xe1109, 0x2000402, 0x85323000, 0x3, 0x1, 0x0
    .long 0x8d500a, 0xd100, 0x4204302, 0x4030402, 0x9410000, 0x3013000, 0x2019000, 0x101d000
    .long 0x8d500b, 0xd100, 0x140e4302, 0x5030503, 0x8413000, 0x18000, 0x301c000, 0x2012000
    .long 0x8d5008, 0xd100, 0x24204301, 0x6030604, 0xb418000, 0x101b000, 0x11000, 0x3015000
    .long 0x8d5009, 0xd100, 0x34204301, 0x7030705, 0xa41b000, 0x2010000, 0x1014000, 0x1a000
    .long 0xb, 0x1f100, 0x11109, 0x2000402, 0x85020000, 0x3, 0x1, 0x0
    .long 0x2000b, 0x1f100, 0x11109, 0x2000402, 0x85121000, 0x3, 0x1, 0x0
    .long 0x4000b, 0x1f100, 0x11109, 0x2000402, 0x85222000, 0x3, 0x1, 0x0
    .long 0x6000b, 0x1f100, 0x11109, 0x2000402, 0x85323000, 0x3, 0x1, 0x0
    .long 0x8000a, 0x1f100, 0x4204302, 0x4030402, 0x9410000, 0x3013000, 0x2019000, 0x101d000
    .long 0x8000b, 0x1f100, 0x14014302, 0x5030503, 0x8413000, 0x18000, 0x301c000, 0x2012000
    .long 0x80008, 0x1f100, 0x24204301, 0x6030604, 0xb418000, 0x101b000, 0x11000, 0x3015000
    .long 0x80009, 0x1f100, 0x34204301, 0x7030705, 0xa41b000, 0x2010000, 0x1014000, 0x1a000
    .long 0xa000b, 0x1f100, 0x11109, 0x2000402, 0x85020000, 0x3, 0x1, 0x0
    .long 0xc000b, 0x1f100, 0x11109, 0x2000402, 0x85121000, 0x3, 0x1, 0x0
    .long 0xe000b, 0x1f100, 0x11109, 0x2000402, 0x85222000, 0x3, 0x1, 0x0
    .long 0x10000b, 0x1f100, 0x11109, 0x2000402, 0x85323000, 0x3, 0x1, 0x0
    .long 0x12000a, 0x100, 0x4204302, 0x4030402, 0x9410000, 0x3013000, 0x2019000, 0x101d000
    .long 0x12000b, 0x100, 0x14014302, 0x5030503, 0x8413000, 0x18000, 0x301c000, 0x2012000
    .long 0x120008, 0x100, 0x24204301, 0x6030604, 0xb418000, 0x101b000, 0x11000, 0x3015000
    .long 0x120009, 0x100, 0x34204301, 0x7030705, 0xa41b000, 0x2010000, 0x1014000, 0x1a000
    .long 0x20800f, 0x1f100, 0x3110d, 0x2000402, 0x85020000, 0x3, 0x1, 0x0
    .long 0x22800f, 0x1f100, 0x3110d, 0x2000402, 0x85121000, 0x3, 0x1, 0x0
    .long 0x24800f, 0x1f100, 0x3110d, 0x2000402, 0x85222000, 0x3, 0x1, 0x0
    .long 0x26800f, 0x1f100, 0x3110d, 0x2000402, 0x85323000, 0x3, 0x1, 0x0
    .long 0x0, 0x0, 0x0, 0x0, 0x0, 0x0, 0x0, 0x0
    .long 0x0, 0x0, 0x0, 0x0, 0x0, 0x0, 0x0, 0x0
    .long 0x0, 0x0, 0x0, 0x0, 0x0, 0x0, 0x0, 0x0
    .long 0x0, 0x0, 0x0, 0x0, 0x0, 0x0, 0x0, 0x0
    .long 0x28800f, 0x1f100, 0x3110d, 0x2000402, 0x85020000, 0x3, 0x1, 0x0
    .long 0x2a800f, 0x1f100, 0x3110d, 0x2000402, 0x85121000, 0x3, 0x1, 0x0
    .long 0x2c800f, 0x1f100, 0x3110d, 0x2000402, 0x85222000, 0x3, 0x1, 0x0
    .long 0x2e800f, 0x1f100, 0x3110d, 0x2000402, 0x85323000, 0x3, 0x1, 0x0
    .long 0x0, 0x0, 0x0, 0x0, 0x0, 0x0, 0x0, 0x0
    .long 0x0, 0x0, 0x0, 0x0, 0x0, 0x0, 0x0, 0x0
    .long 0x0, 0x0, 0x0, 0x0, 0x0, 0x0, 0x0, 0x0
    .long 0x0, 0x0, 0x0, 0x0, 0x0, 0x0, 0x0, 0x0
    .long 0x30800f, 0x1f100, 0x3110d, 0x2000402, 0x85020000, 0x3, 0x1, 0x0
    .long 0x32800f, 0x1f100, 0x3110d, 0x2000402, 0x85121000, 0x3, 0x1, 0x0
    .long 0x34800f, 0x1f100, 0x3110d, 0x2000402, 0x85222000, 0x3, 0x1, 0x0
    .long 0x0, 0x0, 0x0, 0x0, 0x0, 0x0, 0x0, 0x0
    .long 0x0, 0x0, 0x0, 0x0, 0x0, 0x0, 0x0, 0x0
    .long 0x0, 0x0, 0x0, 0x0, 0x0, 0x0, 0x0, 0x0
    .long 0x0, 0x0, 0x0, 0x0, 0x0, 0x0, 0x0, 0x0
    .long 0x0, 0x0, 0x0, 0x0, 0x0, 0x0, 0x0, 0x0
    .long 0x36800f, 0x1f100, 0x3110d, 0x2000402, 0x85020000, 0x3, 0x1, 0x0
    .long 0x38800f, 0x1f100, 0x3110d, 0x2000402, 0x85121000, 0x3, 0x1, 0x0
    .long 0x3a800f, 0x2100, 0x3110d, 0x2000402, 0x85222000, 0x3, 0x1, 0x0
    .long 0x0, 0x0, 0x0, 0x0, 0x0, 0x0, 0x0, 0x0
    .long 0x0, 0x0, 0x0, 0x0, 0x0, 0x0, 0x0, 0x0
    .long 0x0, 0x0, 0x0, 0x0, 0x0, 0x0, 0x0, 0x0
    .long 0x0, 0x0, 0x0, 0x0, 0x0, 0x0, 0x0, 0x0
    .long 0x0, 0x0, 0x0, 0x0, 0x0, 0x0, 0x0, 0x0
L_cnt:
    .long 0, 1, 2, 3, 4, 5, 6, 7, 8, 9, 10, 11, 12, 13, 14, 15, 16, 17, 18, 19, 20, 21, 22, 23, 24, 25, 26, 27, 28, 29, 30, 31
.size L_near, .-L_near
L_codeend:
    .fill 768, 4, 0xbf800000
.section .rodata,"a"
.p2align 6
.amdhsa_kernel standalone__varlen_attn_packed__ragged_kernel
  .amdhsa_next_free_vgpr 256
  .amdhsa_next_free_sgpr 100
  .amdhsa_accum_offset 256
  .amdhsa_group_segment_fixed_size 0
  .amdhsa_kernarg_size 56
  .amdhsa_user_sgpr_count 2
  .amdhsa_user_sgpr_kernarg_segment_ptr 1
  .amdhsa_system_sgpr_workgroup_id_x 1
.end_amdhsa_kernel
```
